```python
import torch

def _softmax(x, axis=-1):
    return torch.softmax(x, dim=axis)
def _gelu(x):
    return torch.nn.functional.gelu(x, approximate="tanh")
def _silu(x):
    return torch.nn.functional.silu(x)
def _sigmoid(x):
    return torch.sigmoid(x)
def _layernorm(x, axis=-1, eps=1e-5):
    m = x.mean(dim=axis, keepdim=True)
    v = x.var(dim=axis, keepdim=True, unbiased=False)
    return (x - m) / torch.sqrt(v + eps)
def _scatter_add(tgt, idx, src, axis=0):
    return tgt.clone().index_add_(axis, idx, src)
def _segment_sum(src, seg, n):
    out = torch.zeros((n,) + src.shape[1:], dtype=src.dtype)
    return out.index_add_(0, seg, src)
def _pad(x, pw):
    flat = tuple(v for pair in reversed(pw) for v in pair)
    return torch.nn.functional.pad(x, flat)

kernel_name = 'gather_scatter__mpnn_edge_mlp__graph'

def setup_inputs():

    _w = (lambda a: (lambda t: t.to(torch.bfloat16) if t.is_floating_point() else t)(torch.as_tensor(a)))
    N, deg, D, De = 10000, 32, 128, max(0, 1)
    E = N * deg
    return {
        "x": _w((lambda *s: torch.randn(*s, dtype=torch.bfloat16) * 0.05)(N, D)),
        "e_attr": _w((lambda *s: torch.randn(*s, dtype=torch.bfloat16) * 0.4)(E, De)),
        "src": _w((lambda lo, hi, *s: torch.randint(lo, hi, s))(0, N, E).to(torch.int64)),
        "dst": _w((lambda lo, hi, *s: torch.randint(lo, hi, s))(0, N, E).to(torch.int64)),
        "w_msg": _w((lambda *s: torch.randn(*s, dtype=torch.bfloat16) * 0.4)(2 * D + De, D)),
        "w_upd": _w((lambda *s: torch.randn(*s, dtype=torch.bfloat16) * 0.05)(2 * D, D)),
    }

def reference(x, e_attr, src, dst, w_msg, w_upd):
    N, D = x.shape
    m_in = torch.concatenate([x[src], x[dst], e_attr], axis=-1)
    msg = _silu(m_in @ w_msg)
    agg = _segment_sum(msg, dst, N)
    return _silu(torch.concatenate([x, agg], axis=-1) @ w_upd)
```

```asm
; @launch kernel=mpnn_k1_kernel grid=(410,1,1) block=(256,1,1) lds=32768
; @launch kernel=mpnn_k2_kernel grid=(256,1,1) block=(1024,1,1) lds=92480
.amdgcn_target "amdgcn-amd-amdhsa--gfx950"
.text
  .globl mpnn_k1_kernel
  .p2align 8
  .type mpnn_k1_kernel,@function
mpnn_k1_kernel:
  s_cmp_ge_u32 s2, 410
  s_cbranch_scc1 K1_END
  s_load_dwordx4 s[4:7], s[0:1], 0
  s_load_dwordx4 s[8:11], s[0:1], 16
  s_load_dwordx4 s[12:15], s[0:1], 32
  s_load_dwordx2 s[16:17], s[0:1], 64
  s_add_u32 s3, s2, 250
  s_sub_u32 s2, s2, 160
  s_cselect_b32 s2, s3, s2
  v_and_b32 v1, 63, v0
  v_lshrrev_b32 v2, 6, v0
  s_cmp_ge_u32 s2, 250
  s_cbranch_scc1 K1_NOTPART
  s_mul_i32 s20, s2, 1280
  v_add_u32 v3, s20, v0
  v_lshlrev_b32 v4, 2, v3
  v_lshlrev_b32 v5, 1, v3
  v_add_u32 v6, 0x1000, v4
  v_lshlrev_b32 v7, 2, v0
  v_mov_b32 v8, 0
  ds_write_b32 v7, v8
  s_waitcnt lgkmcnt(0)
  s_mov_b32 s24, s10
  s_mov_b32 s25, s11
  s_mov_b32 s26, 1280000
  s_mov_b32 s27, 0x00020000
  s_mov_b32 s28, s8
  s_mov_b32 s29, s9
  s_mov_b32 s30, 1280000
  s_mov_b32 s31, 0x00020000
  s_mov_b32 s32, s6
  s_mov_b32 s33, s7
  s_mov_b32 s34, 640000
  s_mov_b32 s35, 0x00020000
  buffer_load_dword v10, v4, s[24:27], 0 offen offset:0
  buffer_load_dword v11, v4, s[24:27], 0 offen offset:1024
  buffer_load_dword v12, v4, s[24:27], 0 offen offset:2048
  buffer_load_dword v13, v4, s[24:27], 0 offen offset:3072
  buffer_load_dword v14, v6, s[24:27], 0 offen
  buffer_load_dword v15, v4, s[28:31], 0 offen offset:0
  buffer_load_dword v16, v4, s[28:31], 0 offen offset:1024
  buffer_load_dword v17, v4, s[28:31], 0 offen offset:2048
  buffer_load_dword v18, v4, s[28:31], 0 offen offset:3072
  buffer_load_dword v19, v6, s[28:31], 0 offen
  buffer_load_ushort v20, v5, s[32:35], 0 offen offset:0
  buffer_load_ushort v21, v5, s[32:35], 0 offen offset:512
  buffer_load_ushort v22, v5, s[32:35], 0 offen offset:1024
  buffer_load_ushort v23, v5, s[32:35], 0 offen offset:1536
  buffer_load_ushort v24, v5, s[32:35], 0 offen offset:2048
  s_add_u32 s24, s16, 2621440
  s_addc_u32 s25, s17, 0
  s_mov_b32 s26, 2560000
  s_mov_b32 s27, 0x00020000
  s_add_u32 s28, s16, 5242880
  s_addc_u32 s29, s17, 0
  s_mov_b32 s30, 262144
  s_mov_b32 s31, 0x00020000
  s_waitcnt lgkmcnt(0)
  s_barrier
  s_mov_b32 s36, 2569926
  s_mov_b32 s37, 1216
  v_mov_b32 v9, 65472
  v_mov_b32 v53, 1
  s_waitcnt vmcnt(14)
  v_mul_u32_u24 v48, 55189, v10
  v_subrev_u32 v50, 1216, v10
  v_lshrrev_b32 v48, 21, v48
  v_mul_u32_u24 v51, 106959, v50
  v_mul_u32_u24 v49, 38, v48
  v_lshrrev_b32 v51, 22, v51
  v_sub_u32 v49, v10, v49
  v_mad_u32_u24 v52, v51, s36, v9
  v_cmp_gt_u32 vcc, s37, v10
  v_lshrrev_b32 v52, 16, v52
  v_add_u32 v51, 32, v51
  v_sub_u32 v50, v50, v52
  v_cndmask_b32 v25, v51, v48, vcc
  v_cndmask_b32 v10, v50, v49, vcc
  v_lshlrev_b32 v10, 2, v10
  v_lshlrev_b32 v25, 2, v25
  ds_add_rtn_u32 v30, v25, v53
  s_waitcnt vmcnt(13)
  v_mul_u32_u24 v48, 55189, v11
  v_subrev_u32 v50, 1216, v11
  v_lshrrev_b32 v48, 21, v48
  v_mul_u32_u24 v51, 106959, v50
  v_mul_u32_u24 v49, 38, v48
  v_lshrrev_b32 v51, 22, v51
  v_sub_u32 v49, v11, v49
  v_mad_u32_u24 v52, v51, s36, v9
  v_cmp_gt_u32 vcc, s37, v11
  v_lshrrev_b32 v52, 16, v52
  v_add_u32 v51, 32, v51
  v_sub_u32 v50, v50, v52
  v_cndmask_b32 v26, v51, v48, vcc
  v_cndmask_b32 v11, v50, v49, vcc
  v_lshlrev_b32 v11, 2, v11
  v_lshlrev_b32 v26, 2, v26
  ds_add_rtn_u32 v31, v26, v53
  s_waitcnt vmcnt(12)
  v_mul_u32_u24 v48, 55189, v12
  v_subrev_u32 v50, 1216, v12
  v_lshrrev_b32 v48, 21, v48
  v_mul_u32_u24 v51, 106959, v50
  v_mul_u32_u24 v49, 38, v48
  v_lshrrev_b32 v51, 22, v51
  v_sub_u32 v49, v12, v49
  v_mad_u32_u24 v52, v51, s36, v9
  v_cmp_gt_u32 vcc, s37, v12
  v_lshrrev_b32 v52, 16, v52
  v_add_u32 v51, 32, v51
  v_sub_u32 v50, v50, v52
  v_cndmask_b32 v27, v51, v48, vcc
  v_cndmask_b32 v12, v50, v49, vcc
  v_lshlrev_b32 v12, 2, v12
  v_lshlrev_b32 v27, 2, v27
  ds_add_rtn_u32 v32, v27, v53
  s_waitcnt vmcnt(11)
  v_mul_u32_u24 v48, 55189, v13
  v_subrev_u32 v50, 1216, v13
  v_lshrrev_b32 v48, 21, v48
  v_mul_u32_u24 v51, 106959, v50
  v_mul_u32_u24 v49, 38, v48
  v_lshrrev_b32 v51, 22, v51
  v_sub_u32 v49, v13, v49
  v_mad_u32_u24 v52, v51, s36, v9
  v_cmp_gt_u32 vcc, s37, v13
  v_lshrrev_b32 v52, 16, v52
  v_add_u32 v51, 32, v51
  v_sub_u32 v50, v50, v52
  v_cndmask_b32 v28, v51, v48, vcc
  v_cndmask_b32 v13, v50, v49, vcc
  v_lshlrev_b32 v13, 2, v13
  v_lshlrev_b32 v28, 2, v28
  ds_add_rtn_u32 v33, v28, v53
  s_waitcnt vmcnt(10)
  v_mul_u32_u24 v48, 55189, v14
  v_subrev_u32 v50, 1216, v14
  v_lshrrev_b32 v48, 21, v48
  v_mul_u32_u24 v51, 106959, v50
  v_mul_u32_u24 v49, 38, v48
  v_lshrrev_b32 v51, 22, v51
  v_sub_u32 v49, v14, v49
  v_mad_u32_u24 v52, v51, s36, v9
  v_cmp_gt_u32 vcc, s37, v14
  v_lshrrev_b32 v52, 16, v52
  v_add_u32 v51, 32, v51
  v_sub_u32 v50, v50, v52
  v_cndmask_b32 v29, v51, v48, vcc
  v_cndmask_b32 v14, v50, v49, vcc
  v_lshlrev_b32 v14, 2, v14
  v_lshlrev_b32 v29, 2, v29
  ds_add_rtn_u32 v34, v29, v53
  s_waitcnt vmcnt(0)
  v_lshlrev_b32 v36, 8, v15
  v_lshl_or_b32 v37, v20, 16, v10
  v_lshlrev_b32 v38, 8, v16
  v_lshl_or_b32 v39, v21, 16, v11
  v_lshlrev_b32 v40, 8, v17
  v_lshl_or_b32 v41, v22, 16, v12
  v_lshlrev_b32 v42, 8, v18
  v_lshl_or_b32 v43, v23, 16, v13
  v_lshlrev_b32 v44, 8, v19
  v_lshl_or_b32 v45, v24, 16, v14
  s_waitcnt lgkmcnt(0)
  s_barrier
  v_lshlrev_b32 v8, 4, v1
  ds_read_b128 v[48:51], v8
  s_waitcnt lgkmcnt(0)
  v_add_u32 v52, v48, v49
  v_add_u32 v53, v52, v50
  v_add_u32 v54, v53, v51
  v_mov_b32 v55, v54
  s_nop 1
  v_add_u32_dpp v55, v55, v55 row_shr:1 row_mask:0xf bank_mask:0xf bound_ctrl:0
  s_nop 1
  v_add_u32_dpp v55, v55, v55 row_shr:2 row_mask:0xf bank_mask:0xf bound_ctrl:0
  s_nop 1
  v_add_u32_dpp v55, v55, v55 row_shr:4 row_mask:0xf bank_mask:0xf bound_ctrl:0
  s_nop 1
  v_add_u32_dpp v55, v55, v55 row_shr:8 row_mask:0xf bank_mask:0xf bound_ctrl:0
  s_nop 1
  v_add_u32_dpp v55, v55, v55 row_bcast:15 row_mask:0xa bank_mask:0xf
  s_nop 1
  v_add_u32_dpp v55, v55, v55 row_bcast:31 row_mask:0xc bank_mask:0xf
  s_nop 1
  v_sub_u32 v56, v55, v54
  v_add_u32 v57, v56, v48
  v_add_u32 v58, v56, v52
  v_add_u32 v59, v56, v53
  ds_write_b128 v8, v[56:59] offset:1024
  ds_read_b32 v60, v7
  ds_read_b32 v61, v7 offset:1024
  ds_read_b32 v48, v25 offset:1024
  ds_read_b32 v49, v26 offset:1024
  ds_read_b32 v50, v27 offset:1024
  ds_read_b32 v51, v28 offset:1024
  ds_read_b32 v52, v29 offset:1024
  s_waitcnt lgkmcnt(0)
  v_add_u32 v48, v48, v30
  v_lshlrev_b32 v48, 3, v48
  ds_write_b64 v48, v[36:37] offset:2048
  v_add_u32 v49, v49, v31
  v_lshlrev_b32 v49, 3, v49
  ds_write_b64 v49, v[38:39] offset:2048
  v_add_u32 v50, v50, v32
  v_lshlrev_b32 v50, 3, v50
  ds_write_b64 v50, v[40:41] offset:2048
  v_add_u32 v51, v51, v33
  v_lshlrev_b32 v51, 3, v51
  ds_write_b64 v51, v[42:43] offset:2048
  v_add_u32 v52, v52, v34
  v_lshlrev_b32 v52, 3, v52
  ds_write_b64 v52, v[44:45] offset:2048
  v_lshl_or_b32 v60, v60, 16, v61
  v_lshlrev_b32 v61, 10, v0
  s_and_b32 s22, s2, 7
  s_lshl_b32 s22, s22, 5
  s_lshr_b32 s21, s2, 3
  s_add_u32 s21, s21, s22
  s_lshl_b32 s21, s21, 2
  buffer_store_dword v60, v61, s[28:31], s21 offen
  s_waitcnt lgkmcnt(0)
  s_barrier
  v_lshlrev_b32 v8, 3, v0
  ds_read_b64 v[36:37], v8 offset:2048
  ds_read_b64 v[38:39], v8 offset:4096
  ds_read_b64 v[40:41], v8 offset:6144
  ds_read_b64 v[42:43], v8 offset:8192
  ds_read_b64 v[44:45], v8 offset:10240
  s_mul_i32 s21, s2, 10240
  v_add_u32 v9, 0x1000, v8
  v_add_u32 v7, 0x2000, v8
  s_waitcnt lgkmcnt(4)
  buffer_store_dwordx2 v[36:37], v8, s[24:27], s21 offen offset:0
  s_waitcnt lgkmcnt(3)
  buffer_store_dwordx2 v[38:39], v8, s[24:27], s21 offen offset:2048
  s_waitcnt lgkmcnt(2)
  buffer_store_dwordx2 v[40:41], v9, s[24:27], s21 offen offset:0
  s_waitcnt lgkmcnt(1)
  buffer_store_dwordx2 v[42:43], v9, s[24:27], s21 offen offset:2048
  s_waitcnt lgkmcnt(0)
  buffer_store_dwordx2 v[44:45], v7, s[24:27], s21 offen offset:0
  s_endpgm
K1_NOTPART:
  v_and_b32 v3, 15, v1
  v_lshrrev_b32 v4, 4, v1
  v_readfirstlane_b32 s3, v2
  s_mov_b32 s40, 0x05040100
  s_mov_b32 s41, 0x07060302
  s_waitcnt lgkmcnt(0)
  s_cmp_ge_u32 s2, 407
  s_cbranch_scc1 K1_PREP
  s_mov_b32 s24, s12
  s_mov_b32 s25, s13
  s_mov_b32 s26, 32768
  s_mov_b32 s27, 0x00020000
  s_mov_b32 s28, s4
  s_mov_b32 s29, s5
  s_mov_b32 s30, 2560000
  s_mov_b32 s31, 0x00020000
  s_mov_b32 s32, s16
  s_mov_b32 s33, s17
  s_mov_b32 s34, 2560000
  s_mov_b32 s35, 0x00020000
  s_sub_u32 s20, s2, 250
  s_lshl_b32 s20, s20, 2
  s_add_u32 s20, s20, s3
  s_lshl_b32 s21, s3, 5
  v_lshl_add_u32 v5, v4, 3, s21
  v_lshlrev_b32 v5, 8, v5
  v_lshl_add_u32 v5, v3, 4, v5
  buffer_load_dwordx4 v[16:19], v5, s[24:27], 0 offen offset:0
  buffer_load_dwordx4 v[20:23], v5, s[24:27], 0 offen offset:256
  buffer_load_dwordx4 v[24:27], v5, s[24:27], 0 offen offset:512
  buffer_load_dwordx4 v[28:31], v5, s[24:27], 0 offen offset:768
  buffer_load_dwordx4 v[32:35], v5, s[24:27], 0 offen offset:1024
  buffer_load_dwordx4 v[36:39], v5, s[24:27], 0 offen offset:1280
  buffer_load_dwordx4 v[40:43], v5, s[24:27], 0 offen offset:1536
  buffer_load_dwordx4 v[44:47], v5, s[24:27], 0 offen offset:1792
  s_lshl_b32 s21, s20, 4
  v_add_u32 v6, s21, v3
  v_lshlrev_b32 v6, 8, v6
  v_lshl_add_u32 v6, v4, 4, v6
  s_add_u32 s44, s3, 0
  s_and_b32 s44, s44, 3
  s_lshl_b32 s48, s44, 6
  buffer_load_dwordx4 v[80:83], v6, s[28:31], s48 offen
  s_add_u32 s45, s3, 1
  s_and_b32 s45, s45, 3
  s_lshl_b32 s49, s45, 6
  buffer_load_dwordx4 v[84:87], v6, s[28:31], s49 offen
  s_add_u32 s46, s3, 2
  s_and_b32 s46, s46, 3
  s_lshl_b32 s50, s46, 6
  buffer_load_dwordx4 v[88:91], v6, s[28:31], s50 offen
  s_add_u32 s47, s3, 3
  s_and_b32 s47, s47, 3
  s_lshl_b32 s51, s47, 6
  buffer_load_dwordx4 v[92:95], v6, s[28:31], s51 offen
  s_waitcnt vmcnt(4)
  v_perm_b32 v48, v20, v16, s40
  v_perm_b32 v49, v28, v24, s40
  v_perm_b32 v50, v36, v32, s40
  v_perm_b32 v51, v44, v40, s40
  v_perm_b32 v52, v20, v16, s41
  v_perm_b32 v53, v28, v24, s41
  v_perm_b32 v54, v36, v32, s41
  v_perm_b32 v55, v44, v40, s41
  v_perm_b32 v56, v21, v17, s40
  v_perm_b32 v57, v29, v25, s40
  v_perm_b32 v58, v37, v33, s40
  v_perm_b32 v59, v45, v41, s40
  v_perm_b32 v60, v21, v17, s41
  v_perm_b32 v61, v29, v25, s41
  v_perm_b32 v62, v37, v33, s41
  v_perm_b32 v63, v45, v41, s41
  v_perm_b32 v64, v22, v18, s40
  v_perm_b32 v65, v30, v26, s40
  v_perm_b32 v66, v38, v34, s40
  v_perm_b32 v67, v46, v42, s40
  v_perm_b32 v68, v22, v18, s41
  v_perm_b32 v69, v30, v26, s41
  v_perm_b32 v70, v38, v34, s41
  v_perm_b32 v71, v46, v42, s41
  v_perm_b32 v72, v23, v19, s40
  v_perm_b32 v73, v31, v27, s40
  v_perm_b32 v74, v39, v35, s40
  v_perm_b32 v75, v47, v43, s40
  v_perm_b32 v76, v23, v19, s41
  v_perm_b32 v77, v31, v27, s41
  v_perm_b32 v78, v39, v35, s41
  v_perm_b32 v79, v47, v43, s41
  s_lshl_b32 s21, s3, 13
  v_lshl_add_u32 v7, v1, 4, s21
  ds_write_b128 v7, v[48:51] offset:0
  ds_write_b128 v7, v[52:55] offset:1024
  ds_write_b128 v7, v[56:59] offset:2048
  ds_write_b128 v7, v[60:63] offset:3072
  ds_write_b128 v7, v[64:67] offset:4096
  ds_write_b128 v7, v[68:71] offset:5120
  ds_write_b128 v7, v[72:75] offset:6144
  ds_write_b128 v7, v[76:79] offset:7168
  s_waitcnt vmcnt(3)
  v_mfma_f32_16x16x32_bf16 v[96:99], v[80:83], v[48:51], 0
  v_mfma_f32_16x16x32_bf16 v[100:103], v[80:83], v[52:55], 0
  v_mfma_f32_16x16x32_bf16 v[104:107], v[80:83], v[56:59], 0
  v_mfma_f32_16x16x32_bf16 v[108:111], v[80:83], v[60:63], 0
  v_mfma_f32_16x16x32_bf16 v[112:115], v[80:83], v[64:67], 0
  v_mfma_f32_16x16x32_bf16 v[116:119], v[80:83], v[68:71], 0
  v_mfma_f32_16x16x32_bf16 v[120:123], v[80:83], v[72:75], 0
  v_mfma_f32_16x16x32_bf16 v[124:127], v[80:83], v[76:79], 0
  s_lshl_b32 s53, s45, 13
  v_lshl_add_u32 v9, v1, 4, s53
  s_lshl_b32 s54, s46, 13
  v_lshl_add_u32 v10, v1, 4, s54
  s_lshl_b32 s55, s47, 13
  v_lshl_add_u32 v11, v1, 4, s55
  s_waitcnt lgkmcnt(0)
  s_barrier
  ds_read_b128 v[16:19], v9 offset:0
  ds_read_b128 v[20:23], v9 offset:1024
  ds_read_b128 v[24:27], v9 offset:2048
  ds_read_b128 v[28:31], v9 offset:3072
  ds_read_b128 v[32:35], v9 offset:4096
  ds_read_b128 v[36:39], v9 offset:5120
  ds_read_b128 v[40:43], v9 offset:6144
  ds_read_b128 v[44:47], v9 offset:7168
  s_waitcnt vmcnt(0)
  ds_read_b128 v[48:51], v10 offset:0
  ds_read_b128 v[52:55], v10 offset:1024
  ds_read_b128 v[56:59], v10 offset:2048
  ds_read_b128 v[60:63], v10 offset:3072
  ds_read_b128 v[64:67], v10 offset:4096
  ds_read_b128 v[68:71], v10 offset:5120
  ds_read_b128 v[72:75], v10 offset:6144
  ds_read_b128 v[76:79], v10 offset:7168
  s_waitcnt lgkmcnt(15)
  v_mfma_f32_16x16x32_bf16 v[96:99], v[84:87], v[16:19], v[96:99]
  s_waitcnt lgkmcnt(14)
  v_mfma_f32_16x16x32_bf16 v[100:103], v[84:87], v[20:23], v[100:103]
  s_waitcnt lgkmcnt(13)
  v_mfma_f32_16x16x32_bf16 v[104:107], v[84:87], v[24:27], v[104:107]
  s_waitcnt lgkmcnt(12)
  v_mfma_f32_16x16x32_bf16 v[108:111], v[84:87], v[28:31], v[108:111]
  s_waitcnt lgkmcnt(11)
  v_mfma_f32_16x16x32_bf16 v[112:115], v[84:87], v[32:35], v[112:115]
  s_waitcnt lgkmcnt(10)
  v_mfma_f32_16x16x32_bf16 v[116:119], v[84:87], v[36:39], v[116:119]
  s_waitcnt lgkmcnt(9)
  v_mfma_f32_16x16x32_bf16 v[120:123], v[84:87], v[40:43], v[120:123]
  s_waitcnt lgkmcnt(8)
  v_mfma_f32_16x16x32_bf16 v[124:127], v[84:87], v[44:47], v[124:127]
  ds_read_b128 v[16:19], v11 offset:0
  ds_read_b128 v[20:23], v11 offset:1024
  ds_read_b128 v[24:27], v11 offset:2048
  ds_read_b128 v[28:31], v11 offset:3072
  ds_read_b128 v[32:35], v11 offset:4096
  ds_read_b128 v[36:39], v11 offset:5120
  ds_read_b128 v[40:43], v11 offset:6144
  ds_read_b128 v[44:47], v11 offset:7168
  s_waitcnt lgkmcnt(15)
  v_mfma_f32_16x16x32_bf16 v[96:99], v[88:91], v[48:51], v[96:99]
  s_waitcnt lgkmcnt(14)
  v_mfma_f32_16x16x32_bf16 v[100:103], v[88:91], v[52:55], v[100:103]
  s_waitcnt lgkmcnt(13)
  v_mfma_f32_16x16x32_bf16 v[104:107], v[88:91], v[56:59], v[104:107]
  s_waitcnt lgkmcnt(12)
  v_mfma_f32_16x16x32_bf16 v[108:111], v[88:91], v[60:63], v[108:111]
  s_waitcnt lgkmcnt(11)
  v_mfma_f32_16x16x32_bf16 v[112:115], v[88:91], v[64:67], v[112:115]
  s_waitcnt lgkmcnt(10)
  v_mfma_f32_16x16x32_bf16 v[116:119], v[88:91], v[68:71], v[116:119]
  s_waitcnt lgkmcnt(9)
  v_mfma_f32_16x16x32_bf16 v[120:123], v[88:91], v[72:75], v[120:123]
  s_waitcnt lgkmcnt(8)
  v_mfma_f32_16x16x32_bf16 v[124:127], v[88:91], v[76:79], v[124:127]
  s_waitcnt lgkmcnt(7)
  v_mfma_f32_16x16x32_bf16 v[96:99], v[92:95], v[16:19], v[96:99]
  s_waitcnt lgkmcnt(6)
  v_mfma_f32_16x16x32_bf16 v[100:103], v[92:95], v[20:23], v[100:103]
  s_waitcnt lgkmcnt(5)
  v_mfma_f32_16x16x32_bf16 v[104:107], v[92:95], v[24:27], v[104:107]
  s_waitcnt lgkmcnt(4)
  v_mfma_f32_16x16x32_bf16 v[108:111], v[92:95], v[28:31], v[108:111]
  s_waitcnt lgkmcnt(3)
  v_mfma_f32_16x16x32_bf16 v[112:115], v[92:95], v[32:35], v[112:115]
  s_waitcnt lgkmcnt(2)
  v_mfma_f32_16x16x32_bf16 v[116:119], v[92:95], v[36:39], v[116:119]
  s_waitcnt lgkmcnt(1)
  v_mfma_f32_16x16x32_bf16 v[120:123], v[92:95], v[40:43], v[120:123]
  s_waitcnt lgkmcnt(0)
  v_mfma_f32_16x16x32_bf16 v[124:127], v[92:95], v[44:47], v[124:127]
  s_lshl_b32 s21, s20, 4
  v_lshl_add_u32 v6, v4, 2, s21
  v_lshlrev_b32 v6, 8, v6
  v_lshl_add_u32 v6, v3, 4, v6
  s_mov_b32 s22, 0xbfb8aa3b
  s_nop 7
  s_mov_b32 s23, s22
  v_pk_mul_f32 v[96:97], v[96:97], s[22:23]
  v_pk_mul_f32 v[100:101], v[100:101], s[22:23]
  v_pk_mul_f32 v[104:105], v[104:105], s[22:23]
  v_pk_mul_f32 v[108:109], v[108:109], s[22:23]
  v_pk_mul_f32 v[112:113], v[112:113], s[22:23]
  v_pk_mul_f32 v[116:117], v[116:117], s[22:23]
  v_pk_mul_f32 v[120:121], v[120:121], s[22:23]
  v_pk_mul_f32 v[124:125], v[124:125], s[22:23]
  v_cvt_pk_bf16_f32 v16, v96, v100
  v_cvt_pk_bf16_f32 v17, v104, v108
  v_cvt_pk_bf16_f32 v18, v112, v116
  v_cvt_pk_bf16_f32 v19, v120, v124
  buffer_store_dwordx4 v[16:19], v6, s[32:35], 0 offen offset:0 sc1
  v_cvt_pk_bf16_f32 v20, v97, v101
  v_cvt_pk_bf16_f32 v21, v105, v109
  v_cvt_pk_bf16_f32 v22, v113, v117
  v_cvt_pk_bf16_f32 v23, v121, v125
  buffer_store_dwordx4 v[20:23], v6, s[32:35], 0 offen offset:256 sc1
  v_pk_mul_f32 v[98:99], v[98:99], s[22:23]
  v_pk_mul_f32 v[102:103], v[102:103], s[22:23]
  v_pk_mul_f32 v[106:107], v[106:107], s[22:23]
  v_pk_mul_f32 v[110:111], v[110:111], s[22:23]
  v_pk_mul_f32 v[114:115], v[114:115], s[22:23]
  v_pk_mul_f32 v[118:119], v[118:119], s[22:23]
  v_pk_mul_f32 v[122:123], v[122:123], s[22:23]
  v_pk_mul_f32 v[126:127], v[126:127], s[22:23]
  v_cvt_pk_bf16_f32 v24, v98, v102
  v_cvt_pk_bf16_f32 v25, v106, v110
  v_cvt_pk_bf16_f32 v26, v114, v118
  v_cvt_pk_bf16_f32 v27, v122, v126
  buffer_store_dwordx4 v[24:27], v6, s[32:35], 0 offen offset:512 sc1
  v_cvt_pk_bf16_f32 v28, v99, v103
  v_cvt_pk_bf16_f32 v29, v107, v111
  v_cvt_pk_bf16_f32 v30, v115, v119
  v_cvt_pk_bf16_f32 v31, v123, v127
  buffer_store_dwordx4 v[28:31], v6, s[32:35], 0 offen offset:768 sc1
  s_endpgm
K1_PREP:
  s_sub_u32 s20, s2, 407
  s_cmp_eq_u32 s20, 0
  s_cselect_b32 s24, s12, s14
  s_cselect_b32 s25, s13, s15
  s_cmp_eq_u32 s20, 1
  s_cselect_b32 s21, 0, 0x8000
  s_add_u32 s24, s24, s21
  s_addc_u32 s25, s25, 0
  s_mov_b32 s26, 0x8000
  s_mov_b32 s27, 0x00020000
  s_add_u32 s28, s16, 5505024
  s_addc_u32 s29, s17, 0
  s_mov_b32 s30, 98304
  s_mov_b32 s31, 0x00020000
  s_lshl_b32 s21, s3, 5
  v_lshl_add_u32 v5, v4, 3, s21
  s_cmp_eq_u32 s20, 2
  s_cbranch_scc1 K1_PREP_PERM
  v_lshlrev_b32 v5, 8, v5
  v_lshl_add_u32 v5, v3, 4, v5
  buffer_load_dwordx4 v[16:19], v5, s[24:27], 0 offen offset:0
  buffer_load_dwordx4 v[20:23], v5, s[24:27], 0 offen offset:256
  buffer_load_dwordx4 v[24:27], v5, s[24:27], 0 offen offset:512
  buffer_load_dwordx4 v[28:31], v5, s[24:27], 0 offen offset:768
  buffer_load_dwordx4 v[32:35], v5, s[24:27], 0 offen offset:1024
  buffer_load_dwordx4 v[36:39], v5, s[24:27], 0 offen offset:1280
  buffer_load_dwordx4 v[40:43], v5, s[24:27], 0 offen offset:1536
  buffer_load_dwordx4 v[44:47], v5, s[24:27], 0 offen offset:1792
  s_branch K1_PREP_GO
K1_PREP_PERM:
  v_and_b32 v5, 63, v5
  v_lshlrev_b32 v5, 1, v5
  s_lshr_b32 s21, s3, 1
  v_add_u32 v5, s21, v5
  v_lshlrev_b32 v5, 8, v5
  v_lshl_add_u32 v5, v3, 4, v5
  buffer_load_dwordx4 v[16:19], v5, s[24:27], 0 offen offset:0
  buffer_load_dwordx4 v[20:23], v5, s[24:27], 0 offen offset:512
  buffer_load_dwordx4 v[24:27], v5, s[24:27], 0 offen offset:1024
  buffer_load_dwordx4 v[28:31], v5, s[24:27], 0 offen offset:1536
  buffer_load_dwordx4 v[32:35], v5, s[24:27], 0 offen offset:2048
  buffer_load_dwordx4 v[36:39], v5, s[24:27], 0 offen offset:2560
  buffer_load_dwordx4 v[40:43], v5, s[24:27], 0 offen offset:3072
  buffer_load_dwordx4 v[44:47], v5, s[24:27], 0 offen offset:3584
K1_PREP_GO:
  v_lshrrev_b32 v6, 2, v3
  v_lshlrev_b32 v6, 13, v6
  v_and_b32 v7, 3, v3
  v_lshlrev_b32 v7, 6, v7
  v_add_u32 v6, v6, v7
  v_lshl_add_u32 v6, v4, 8, v6
  s_lshl_b32 s21, s20, 15
  s_lshl_b32 s22, s3, 10
  s_add_u32 s21, s21, s22
  v_add_u32 v6, s21, v6
  v_add_u32 v7, 0x1000, v6
  s_waitcnt vmcnt(0)
  v_perm_b32 v48, v20, v16, s40
  v_perm_b32 v49, v28, v24, s40
  v_perm_b32 v50, v36, v32, s40
  v_perm_b32 v51, v44, v40, s40
  v_perm_b32 v52, v20, v16, s41
  v_perm_b32 v53, v28, v24, s41
  v_perm_b32 v54, v36, v32, s41
  v_perm_b32 v55, v44, v40, s41
  v_perm_b32 v56, v21, v17, s40
  v_perm_b32 v57, v29, v25, s40
  v_perm_b32 v58, v37, v33, s40
  v_perm_b32 v59, v45, v41, s40
  v_perm_b32 v60, v21, v17, s41
  v_perm_b32 v61, v29, v25, s41
  v_perm_b32 v62, v37, v33, s41
  v_perm_b32 v63, v45, v41, s41
  v_perm_b32 v64, v22, v18, s40
  v_perm_b32 v65, v30, v26, s40
  v_perm_b32 v66, v38, v34, s40
  v_perm_b32 v67, v46, v42, s40
  v_perm_b32 v68, v22, v18, s41
  v_perm_b32 v69, v30, v26, s41
  v_perm_b32 v70, v38, v34, s41
  v_perm_b32 v71, v46, v42, s41
  v_perm_b32 v72, v23, v19, s40
  v_perm_b32 v73, v31, v27, s40
  v_perm_b32 v74, v39, v35, s40
  v_perm_b32 v75, v47, v43, s40
  v_perm_b32 v76, v23, v19, s41
  v_perm_b32 v77, v31, v27, s41
  v_perm_b32 v78, v39, v35, s41
  v_perm_b32 v79, v47, v43, s41
  buffer_store_dwordx4 v[48:51], v6, s[28:31], 0 offen offset:0
  buffer_store_dwordx4 v[52:55], v6, s[28:31], 0 offen offset:16
  buffer_store_dwordx4 v[56:59], v6, s[28:31], 0 offen offset:32
  buffer_store_dwordx4 v[60:63], v6, s[28:31], 0 offen offset:48
  buffer_store_dwordx4 v[64:67], v7, s[28:31], 0 offen offset:0
  buffer_store_dwordx4 v[68:71], v7, s[28:31], 0 offen offset:16
  buffer_store_dwordx4 v[72:75], v7, s[28:31], 0 offen offset:32
  buffer_store_dwordx4 v[76:79], v7, s[28:31], 0 offen offset:48
K1_END:
  s_endpgm
  .section .rodata,"a"
  .p2align 6
  .amdhsa_kernel mpnn_k1_kernel
  .amdhsa_next_free_vgpr 128
  .amdhsa_next_free_sgpr 102
  .amdhsa_accum_offset 128
  .amdhsa_group_segment_fixed_size 0
  .amdhsa_kernarg_size 72
  .amdhsa_user_sgpr_count 2
  .amdhsa_user_sgpr_kernarg_segment_ptr 1
  .amdhsa_system_sgpr_workgroup_id_x 1
  .amdhsa_float_denorm_mode_32 3
  .end_amdhsa_kernel
  .text
  .globl mpnn_k2_kernel
  .p2align 8
  .type mpnn_k2_kernel,@function
mpnn_k2_kernel:
  s_cmp_ge_u32 s2, 256
  s_cbranch_scc1 K2_END
  s_load_dwordx2 s[10:11], s[0:1], 64
  s_load_dwordx16 s[16:31], s[0:1], 0
  s_and_b32 s55, s2, 7
  s_lshr_b32 s51, s2, 3
  s_lshl_b32 s2, s55, 5
  s_add_u32 s2, s2, s51
  s_sub_u32 s56, s2, 32
  s_mul_i32 s88, s56, 2569926
  s_add_u32 s89, s88, 2635398
  s_add_u32 s88, s88, 65472
  s_lshr_b32 s88, s88, 16
  s_lshr_b32 s89, s89, 16
  s_sub_u32 s89, s89, s88
  s_add_u32 s88, s88, 1216
  s_mul_i32 s56, s51, 38
  s_cmp_eq_u32 s55, 0
  s_cselect_b32 s88, s56, s88
  s_cselect_b32 s89, 38, s89
  v_and_b32 v1, 63, v0
  v_lshrrev_b32 v16, 6, v0
  v_mul_u32_u24 v17, 21846, v0
  v_lshrrev_b32 v17, 16, v17
  v_readfirstlane_b32 s3, v16
  v_lshlrev_b32 v18, 4, v0
  v_lshlrev_b32 v117, 2, v1
  v_lshlrev_b32 v15, 4, v1
  v_add_u32 v24, 0x10000, v117
  v_add_u32 v25, 0x1000, v15
  s_lshl_b32 s55, s2, 10
  s_add_u32 s55, s55, 5242880
  s_lshl_b32 s56, s88, 8
  s_and_b32 s59, s3, 3
  s_lshl_b32 s59, s59, 13
  v_lshlrev_b32 v26, 2, v17
  s_waitcnt lgkmcnt(0)
  s_add_u32 s20, s10, s55
  s_addc_u32 s21, s11, 0
  s_cmp_ge_u32 s3, 12
  s_cbranch_scc1 K2_NOOFFS
  global_load_dword v11, v26, s[20:21]
K2_NOOFFS:
  global_load_dword v116, v24, s[24:25]
  s_add_u32 s18, s16, s56
  s_addc_u32 s19, s17, 0
  s_mov_b64 s[6:7], s[24:25]
  s_mov_b64 s[8:9], s[28:29]
  s_cmp_ge_u32 s3, 10
  s_cbranch_scc1 K2_NOX
  s_lshl_b32 s66, s89, 4
  v_cmp_gt_u32 vcc, s66, v0
  s_and_saveexec_b64 s[64:65], vcc
  global_load_dwordx4 v[20:23], v18, s[18:19]
  s_mov_b64 exec, s[64:65]
K2_NOX:
  s_add_u32 s4, s10, 5505024
  s_addc_u32 s5, s11, 0
  s_cmp_lt_u32 s3, 12
  s_cbranch_scc1 K2_NOW
  s_add_u32 s20, s4, s59
  s_addc_u32 s21, s5, 0
  global_load_dwordx4 v[56:59], v15, s[20:21] offset:0
  global_load_dwordx4 v[60:63], v15, s[20:21] offset:1024
  global_load_dwordx4 v[64:67], v15, s[20:21] offset:2048
  global_load_dwordx4 v[68:71], v15, s[20:21] offset:3072
  global_load_dwordx4 v[72:75], v25, s[20:21] offset:0
  global_load_dwordx4 v[76:79], v25, s[20:21] offset:1024
  global_load_dwordx4 v[80:83], v25, s[20:21] offset:2048
  global_load_dwordx4 v[84:87], v25, s[20:21] offset:3072
K2_NOWX:
K2_NOW:
  v_mov_b32 v28, 0
  v_mov_b32 v29, 0
  v_mov_b32 v30, 0
  v_mov_b32 v31, 0
  ds_write_b128 v18, v[28:31] offset:0
  ds_write_b128 v18, v[28:31] offset:16384
  ds_write_b128 v18, v[28:31] offset:32768
  v_mov_b32 v26, 60
  v_cmp_gt_u32 vcc, v26, v0
  s_and_saveexec_b64 s[64:65], vcc
  ds_write_b128 v18, v[28:31] offset:49152
  s_mov_b64 exec, s[64:65]
  s_add_u32 s12, s10, 0
  s_addc_u32 s13, s11, 0
  s_or_b32 s13, s13, 0x00040000
  s_mov_b32 s14, 2560000
  s_mov_b32 s15, 0x00800000
  s_mov_b32 s40, 0
  s_mov_b32 s90, 0
  v_mov_b32 v123, 0
  v_mov_b32 v124, 0
  v_mov_b32 v125, 0
  s_mov_b32 s57, 0x7b800000
  s_mov_b32 s36, 1.0
  s_mov_b32 s37, 1.0
  v_add_u32 v9, 28992, v117
  v_lshlrev_b32 v10, 3, v1
  v_add_u32 v10, 63168, v10
  v_mul_u32_u24 v114, 3, v17
  v_sub_u32 v114, v0, v114
  v_and_b32 v26, 31, v17
  v_lshrrev_b32 v27, 5, v17
  v_lshl_add_u32 v26, v26, 3, v27
  v_mov_b32 v27, 250
  v_cmp_gt_u32 s[22:23], v27, v26
  v_mul_u32_u24 v26, 10240, v26
  v_lshl_add_u32 v112, v114, 4, v26
  v_lshlrev_b32 v114, 1, v114
  v_and_b32 v26, 15, v1
  v_lshrrev_b32 v27, 4, v1
  v_lshrrev_b32 v28, 2, v26
  v_cmp_eq_u32 s[38:39], v27, v28
  v_and_b32 v29, 1, v26
  v_bfe_u32 v30, v26, 1, 1
  v_lshlrev_b32 v31, 4, v29
  v_mov_b32 v27, 0x3f80
  v_lshlrev_b32 v27, v31, v27
  v_cmp_eq_u32 vcc, 0, v30
  v_cndmask_b32 v27, 0, v27, s[38:39]
  v_lshlrev_b32 v31, 2, v29
  v_sub_u32 v31, 8452, v31
  v_lshl_add_u32 v31, v30, 4, v31
  v_cndmask_b32 v40, 0, v27, vcc
  v_cndmask_b32 v41, v27, 0, vcc
  v_mov_b32 v28, 27968
  v_cndmask_b32 v113, v28, v31, s[38:39]
  v_cndmask_b32 v115, 0, 32, s[38:39]
  v_mov_b32 v44, v40
  v_mov_b32 v45, v41
  v_lshlrev_b32 v4, 2, v115
  v_and_b32 v26, 15, v1
  v_lshrrev_b32 v27, 4, v1
  v_mul_u32_u24 v12, 272, v26
  v_lshl_add_u32 v12, v27, 4, v12
  v_mul_u32_u24 v13, 528, v26
  v_lshl_add_u32 v13, v27, 5, v13
  s_and_b32 s55, s3, 3
  s_lshl_b32 s55, s55, 7
  s_add_u32 s55, s55, 63168
  v_add_u32 v13, s55, v13
  v_cmp_gt_u32 s[68:69], 8, v26
  s_add_u32 s16, s10, 2621440
  s_addc_u32 s17, s11, 0
  s_mov_b32 s42, 24
  s_cmp_ge_u32 s3, 12
  s_cbranch_scc1 K2_WVW
  s_waitcnt vmcnt(0)
K2_ROUND:
  v_lshrrev_b32 v118, 16, v11
  v_and_b32 v27, 0xffff, v11
  v_sub_u32 v118, v118, v114
  v_add_u32 v27, s40, v27
  v_subrev_u32 v118, s40, v118
  v_lshl_add_u32 v27, v27, 3, v112
  v_cmp_lt_i32 s[24:25], 0, v118
  v_cmp_lt_i32 s[26:27], 1, v118
  v_cmp_lt_i32 s[28:29], 6, v118
  v_cmp_lt_i32 s[30:31], 7, v118
  v_cmp_lt_i32 s[32:33], 12, v118
  v_cmp_lt_i32 s[34:35], 13, v118
  v_cmp_lt_i32 s[92:93], 18, v118
  v_cmp_lt_i32 s[94:95], 19, v118
  v_cmp_lt_i32 s[60:61], 24, v118
  s_and_b64 s[24:25], s[24:25], s[22:23]
  s_and_b64 s[26:27], s[26:27], s[22:23]
  s_and_b64 s[28:29], s[28:29], s[22:23]
  s_and_b64 s[30:31], s[30:31], s[22:23]
  s_and_b64 s[32:33], s[32:33], s[22:23]
  s_and_b64 s[34:35], s[34:35], s[22:23]
  s_and_b64 s[92:93], s[92:93], s[22:23]
  s_and_b64 s[94:95], s[94:95], s[22:23]
  s_mov_b64 exec, s[24:25]
  s_cbranch_execz K2_NOL0x
  global_load_dwordx4 v[88:91], v27, s[16:17] offset:0
K2_NOL0x:
  s_mov_b64 exec, s[28:29]
  s_cbranch_execz K2_NOL1x
  global_load_dwordx4 v[92:95], v27, s[16:17] offset:48
K2_NOL1x:
  s_or_b64 s[86:87], s[32:33], s[92:93]
  s_cbranch_scc0 K2_NOL3
  s_mov_b64 exec, s[32:33]
  s_cbranch_execz K2_NOL2x
  global_load_dwordx4 v[96:99], v27, s[16:17] offset:96
K2_NOL2x:
  s_mov_b64 exec, s[92:93]
  s_cbranch_execz K2_NOL3x
  global_load_dwordx4 v[100:103], v27, s[16:17] offset:144
K2_NOL3x:
K2_NOL3:
  s_mov_b64 exec, -1
  s_and_b64 s[60:61], s[60:61], s[22:23]
  s_cmp_lg_u32 s40, 0
  s_cbranch_scc1 K2_R2
  s_cmp_ge_u32 s3, 10
  s_cbranch_scc1 K2_NOX2
  v_lshrrev_b32 v26, 4, v0
  v_and_b32 v28, 15, v0
  v_mul_u32_u24 v26, 272, v26
  v_lshl_add_u32 v26, v28, 4, v26
  ds_write_b128 v26, v[20:23] offset:50112
K2_NOX2:
  s_waitcnt lgkmcnt(0)
  s_barrier
  v_lshlrev_b32 v28, 16, v116
  v_and_b32 v29, 0xffff0000, v116
  s_mov_b32 s55, 0xbfb8aa3b
  v_mul_f32 v28, s55, v28
  v_mul_f32 v29, s55, v29
  v_cvt_pk_bf16_f32 v119, v28, v29
  v_mov_b32 v58, v119
  v_mov_b32 v59, 0
  v_mov_b32 v63, v119
  v_mov_b32 v62, 0
  v_mov_b32 v66, v119
  v_mov_b32 v67, 0
  v_mov_b32 v71, v119
  v_mov_b32 v70, 0
  v_mov_b32 v74, v119
  v_mov_b32 v75, 0
  v_mov_b32 v79, v119
  v_mov_b32 v78, 0
  v_mov_b32 v82, v119
  v_mov_b32 v83, 0
  v_mov_b32 v87, v119
  v_mov_b32 v86, 0
  s_cmp_ge_u32 s3, 5
  s_cbranch_scc1 K2_R2
  s_mul_i32 s55, s51, 81920
  s_lshl_b32 s56, s3, 13
  s_add_u32 s55, s55, s56
  s_add_u32 s18, s10, s55
  s_addc_u32 s19, s11, 0
  v_lshlrev_b32 v24, 7, v1
  global_load_dword v127, v24, s[18:19]
  s_waitcnt vmcnt(1)
  s_branch K2_R3
K2_R2:
  s_waitcnt vmcnt(0)
K2_R3:
  s_mov_b32 s42, 24
  s_cmp_eq_u64 s[60:61], 0
  s_cbranch_scc1 K2_HIST
  v_mov_b32 v26, 27964
  v_mov_b32 v27, 1
  ds_write_b32 v26, v27
K2_HIST:
  v_mov_b32 v27, 4
  v_and_b32 v108, 0xfc, v89
  v_and_b32 v109, 0xfc, v91
  v_and_b32 v110, 0xfc, v93
  v_and_b32 v111, 0xfc, v95
  s_mov_b64 exec, s[24:25]
  ds_add_rtn_u32 v104, v108, v27 offset:27712
  s_mov_b64 exec, s[26:27]
  ds_add_rtn_u32 v105, v109, v27 offset:27712
  s_mov_b64 exec, s[28:29]
  ds_add_rtn_u32 v106, v110, v27 offset:27712
  s_mov_b64 exec, s[30:31]
  ds_add_rtn_u32 v107, v111, v27 offset:27712
  s_cmp_eq_u64 s[86:87], 0
  s_cbranch_scc1 K2_HX
  s_mov_b64 exec, -1
  v_and_b32 v36, 0xfc, v97
  v_and_b32 v37, 0xfc, v99
  v_and_b32 v38, 0xfc, v101
  v_and_b32 v39, 0xfc, v103
  s_mov_b64 exec, s[32:33]
  ds_add_rtn_u32 v32, v36, v27 offset:27712
  s_mov_b64 exec, s[34:35]
  ds_add_rtn_u32 v33, v37, v27 offset:27712
  s_mov_b64 exec, s[92:93]
  ds_add_rtn_u32 v34, v38, v27 offset:27712
  s_mov_b64 exec, s[94:95]
  ds_add_rtn_u32 v35, v39, v27 offset:27712
K2_HX:
  s_mov_b64 exec, -1
  s_branch K2_B2
K2_WVW:
  s_mov_b64 s[24:25], 0
  s_mov_b64 s[26:27], 0
  s_mov_b64 s[28:29], 0
  s_mov_b64 s[30:31], 0
  s_mov_b64 s[32:33], 0
  s_mov_b64 s[34:35], 0
  s_mov_b64 s[92:93], 0
  s_mov_b64 s[94:95], 0
  s_mov_b64 s[60:61], 0
  s_mov_b64 s[86:87], 0
  v_mov_b32 v11, 0
  s_mov_b32 s90, 1
  s_waitcnt lgkmcnt(0)
  s_barrier
  ds_read_b128 v[88:91], v12 offset:50112
  ds_read_b128 v[92:95], v12 offset:50176
  ds_read_b128 v[96:99], v12 offset:50240
  ds_read_b128 v[100:103], v12 offset:50304
  ds_read_b128 v[104:107], v12 offset:54464
  ds_read_b128 v[108:111], v12 offset:54528
  ds_read_b128 v[48:51], v12 offset:54592
  ds_read_b128 v[52:55], v12 offset:54656
  ds_read_b128 v[120:123], v12 offset:58816
  ds_read_b128 v[124:127], v12 offset:58880
K2_B2:
  s_waitcnt lgkmcnt(0)
  s_barrier
  s_cmp_eq_u32 s90, 1
  s_cbranch_scc1 K2_QG
  ds_read_b32 v16, v117 offset:27712
  s_waitcnt lgkmcnt(0)
  v_add_u32 v17, 12, v16
  v_readlane_b32 s41, v16, 63
  v_and_b32 v17, -16, v17
  v_mov_b32 v18, v17
  s_nop 1
  v_add_u32_dpp v18, v18, v18 row_shr:1 row_mask:0xf bank_mask:0xf bound_ctrl:0
  s_nop 1
  v_add_u32_dpp v18, v18, v18 row_shr:2 row_mask:0xf bank_mask:0xf bound_ctrl:0
  s_nop 1
  v_add_u32_dpp v18, v18, v18 row_shr:4 row_mask:0xf bank_mask:0xf bound_ctrl:0
  s_nop 1
  v_add_u32_dpp v18, v18, v18 row_shr:8 row_mask:0xf bank_mask:0xf bound_ctrl:0
  s_nop 1
  v_add_u32_dpp v18, v18, v18 row_bcast:15 row_mask:0xa bank_mask:0xf
  s_nop 1
  v_add_u32_dpp v18, v18, v18 row_bcast:31 row_mask:0xc bank_mask:0xf
  s_nop 1
  v_readlane_b32 s43, v18, 63
  v_sub_u32 v18, v18, v17
  ds_write_b32 v117, v18 offset:28736
  s_cmp_gt_u32 s43, 8192
  s_cbranch_scc1 K2_OVER
  s_lshr_b32 s43, s43, 4
  ds_read_b32 v20, v108 offset:28736
  ds_read_b32 v21, v109 offset:28736
  ds_read_b32 v22, v110 offset:28736
  ds_read_b32 v23, v111 offset:28736
  s_cmp_eq_u64 s[86:87], 0
  s_cbranch_scc1 K2_TX
  ds_read_b32 v24, v36 offset:28736
  ds_read_b32 v25, v37 offset:28736
  ds_read_b32 v26, v38 offset:28736
  ds_read_b32 v27, v39 offset:28736
K2_TX:
  s_mov_b64 exec, -1
  s_cmp_ge_u32 s3, 12
  s_cbranch_scc1 K2_RANGE
  s_lshl_b32 s55, s3, 4
  v_lshrrev_b32 v28, 2, v18
  s_lshl_b32 s56, s3, 2
  v_add_u32 v28, s56, v28
  v_and_b32 v29, -4, v16
  v_subrev_u32 v29, s55, v29
K2_I0:
  v_cmp_lt_i32 vcc, 0, v29
  s_and_b64 exec, exec, vcc
  s_cbranch_execz K2_I1
  v_lshl_or_b32 v30, v29, 6, v117
  ds_write_b32 v28, v30 offset:25344
  v_add_u32 v28, 48, v28
  v_add_u32 v29, 0xffffff40, v29
  s_branch K2_I0
K2_I1:
  s_mov_b64 exec, -1
K2_RANGE:
  s_mul_i32 s44, s43, s3
  s_lshr_b32 s44, s44, 4
  s_add_u32 s55, s3, 1
  s_mul_i32 s55, s43, s55
  s_lshr_b32 s55, s55, 4
  s_sub_u32 s45, s55, s44
  s_lshl_b32 s55, s44, 2
  v_add_u32 v6, s55, v117
  s_lshl_b32 s55, s44, 4
  v_mov_b32 v2, s55
  v_mad_u32_u24 v3, s44, v115, v113
  s_mov_b32 s46, 0
  s_mov_b32 s47, 0
  s_waitcnt lgkmcnt(0)
  s_mov_b64 exec, s[24:25]
  v_add_u32 v28, v20, v104
  v_and_b32 v30, 0xffff0000, v89
  v_lshrrev_b32 v31, 16, v89
  v_lshlrev_b32 v29, 1, v28
  ds_write_b32 v28, v88 offset:0
  ds_write_b64 v29, v[30:31] offset:8448
  s_mov_b64 exec, s[26:27]
  v_add_u32 v28, v21, v105
  v_and_b32 v30, 0xffff0000, v91
  v_lshrrev_b32 v31, 16, v91
  v_lshlrev_b32 v29, 1, v28
  ds_write_b32 v28, v90 offset:0
  ds_write_b64 v29, v[30:31] offset:8448
  s_mov_b64 exec, s[28:29]
  v_add_u32 v28, v22, v106
  v_and_b32 v30, 0xffff0000, v93
  v_lshrrev_b32 v31, 16, v93
  v_lshlrev_b32 v29, 1, v28
  ds_write_b32 v28, v92 offset:0
  ds_write_b64 v29, v[30:31] offset:8448
  s_mov_b64 exec, s[30:31]
  v_add_u32 v28, v23, v107
  v_and_b32 v30, 0xffff0000, v95
  v_lshrrev_b32 v31, 16, v95
  v_lshlrev_b32 v29, 1, v28
  ds_write_b32 v28, v94 offset:0
  ds_write_b64 v29, v[30:31] offset:8448
  s_cmp_eq_u64 s[86:87], 0
  s_cbranch_scc1 K2_SX
  s_mov_b64 exec, s[32:33]
  v_add_u32 v28, v24, v32
  v_and_b32 v30, 0xffff0000, v97
  v_lshrrev_b32 v31, 16, v97
  v_lshlrev_b32 v29, 1, v28
  ds_write_b32 v28, v96 offset:0
  ds_write_b64 v29, v[30:31] offset:8448
  s_mov_b64 exec, s[34:35]
  v_add_u32 v28, v25, v33
  v_and_b32 v30, 0xffff0000, v99
  v_lshrrev_b32 v31, 16, v99
  v_lshlrev_b32 v29, 1, v28
  ds_write_b32 v28, v98 offset:0
  ds_write_b64 v29, v[30:31] offset:8448
  s_mov_b64 exec, s[92:93]
  v_add_u32 v28, v26, v34
  v_and_b32 v30, 0xffff0000, v101
  v_lshrrev_b32 v31, 16, v101
  v_lshlrev_b32 v29, 1, v28
  ds_write_b32 v28, v100 offset:0
  ds_write_b64 v29, v[30:31] offset:8448
  s_mov_b64 exec, s[94:95]
  v_add_u32 v28, v27, v35
  v_and_b32 v30, 0xffff0000, v103
  v_lshrrev_b32 v31, 16, v103
  v_lshlrev_b32 v29, 1, v28
  ds_write_b32 v28, v102 offset:0
  ds_write_b64 v29, v[30:31] offset:8448
K2_SX:
  s_mov_b64 exec, -1
  s_branch K2_B3
K2_QG:
  s_setprio 3
  ds_read_b32 v5, v117 offset:27712
  s_mov_b32 s59, 0xbfb8aa3b
  s_waitcnt vmcnt(0) lgkmcnt(1)
  v_mfma_f32_16x16x32_bf16 v[16:19], v[56:59], v[88:91], 0
  v_mfma_f32_16x16x32_bf16 v[20:23], v[72:75], v[88:91], 0
  v_mfma_f32_16x16x32_bf16 v[16:19], v[60:63], v[92:95], v[16:19]
  v_mfma_f32_16x16x32_bf16 v[20:23], v[76:79], v[92:95], v[20:23]
  ds_read_b128 v[88:91], v12 offset:58944
  ds_read_b128 v[92:95], v12 offset:59008
  v_mfma_f32_16x16x32_bf16 v[16:19], v[64:67], v[96:99], v[16:19]
  v_mfma_f32_16x16x32_bf16 v[20:23], v[80:83], v[96:99], v[20:23]
  v_mfma_f32_16x16x32_bf16 v[16:19], v[68:71], v[100:103], v[16:19]
  v_mfma_f32_16x16x32_bf16 v[20:23], v[84:87], v[100:103], v[20:23]
  s_waitcnt lgkmcnt(2)
  v_add_u32 v7, 12, v5
  v_and_b32 v7, -16, v7
  v_mov_b32 v8, v7
  v_readlane_b32 s41, v5, 63
  v_mfma_f32_16x16x32_bf16 v[24:27], v[56:59], v[104:107], 0
  v_mfma_f32_16x16x32_bf16 v[28:31], v[72:75], v[104:107], 0
  v_add_u32_dpp v8, v8, v8 row_shr:1 row_mask:0xf bank_mask:0xf bound_ctrl:0
  v_mfma_f32_16x16x32_bf16 v[24:27], v[60:63], v[108:111], v[24:27]
  v_mfma_f32_16x16x32_bf16 v[28:31], v[76:79], v[108:111], v[28:31]
  v_add_u32_dpp v8, v8, v8 row_shr:2 row_mask:0xf bank_mask:0xf bound_ctrl:0
  v_mfma_f32_16x16x32_bf16 v[24:27], v[64:67], v[48:51], v[24:27]
  v_mfma_f32_16x16x32_bf16 v[28:31], v[80:83], v[48:51], v[28:31]
  v_add_u32_dpp v8, v8, v8 row_shr:4 row_mask:0xf bank_mask:0xf bound_ctrl:0
  v_mfma_f32_16x16x32_bf16 v[24:27], v[68:71], v[52:55], v[24:27]
  v_mfma_f32_16x16x32_bf16 v[28:31], v[84:87], v[52:55], v[28:31]
  v_add_u32_dpp v8, v8, v8 row_shr:8 row_mask:0xf bank_mask:0xf bound_ctrl:0
  v_mfma_f32_16x16x32_bf16 v[32:35], v[56:59], v[120:123], 0
  v_mfma_f32_16x16x32_bf16 v[36:39], v[72:75], v[120:123], 0
  v_add_u32_dpp v8, v8, v8 row_bcast:15 row_mask:0xa bank_mask:0xf
  v_mfma_f32_16x16x32_bf16 v[32:35], v[60:63], v[124:127], v[32:35]
  v_mfma_f32_16x16x32_bf16 v[36:39], v[76:79], v[124:127], v[36:39]
  v_add_u32_dpp v8, v8, v8 row_bcast:31 row_mask:0xc bank_mask:0xf
  s_waitcnt lgkmcnt(0)
  v_mfma_f32_16x16x32_bf16 v[32:35], v[64:67], v[88:91], v[32:35]
  v_mfma_f32_16x16x32_bf16 v[36:39], v[80:83], v[88:91], v[36:39]
  v_mfma_f32_16x16x32_bf16 v[32:35], v[68:71], v[92:95], v[32:35]
  v_mfma_f32_16x16x32_bf16 v[36:39], v[84:87], v[92:95], v[36:39]
  v_readlane_b32 s43, v8, 63
  v_mul_f32 v16, s59, v16
  v_mul_f32 v17, s59, v17
  v_mul_f32 v18, s59, v18
  v_mul_f32 v19, s59, v19
  v_mul_f32 v20, s59, v20
  v_mul_f32 v21, s59, v21
  v_mul_f32 v22, s59, v22
  v_mul_f32 v23, s59, v23
  ds_write_b128 v13, v[16:19] offset:0
  ds_write_b128 v13, v[20:23] offset:16
  v_mul_f32 v24, s59, v24
  v_mul_f32 v25, s59, v25
  v_mul_f32 v26, s59, v26
  v_mul_f32 v27, s59, v27
  v_mul_f32 v28, s59, v28
  v_mul_f32 v29, s59, v29
  v_mul_f32 v30, s59, v30
  v_mul_f32 v31, s59, v31
  ds_write_b128 v13, v[24:27] offset:8448
  ds_write_b128 v13, v[28:31] offset:8464
  s_nop 0
  v_mul_f32 v32, s59, v32
  v_mul_f32 v33, s59, v33
  v_mul_f32 v34, s59, v34
  v_mul_f32 v35, s59, v35
  v_mul_f32 v36, s59, v36
  v_mul_f32 v37, s59, v37
  v_mul_f32 v38, s59, v38
  v_mul_f32 v39, s59, v39
  s_mov_b64 exec, s[68:69]
  ds_write_b128 v13, v[32:35] offset:16896
  ds_write_b128 v13, v[36:39] offset:16912
  s_mov_b64 exec, -1
  v_lshlrev_b32 v28, 16, v116
  v_and_b32 v29, 0xffff0000, v116
  s_mov_b32 s55, 0xbfb8aa3b
  v_mul_f32 v28, s55, v28
  v_mul_f32 v29, s55, v29
  v_cvt_pk_bf16_f32 v119, v28, v29
  v_mov_b32 v58, v119
  v_mov_b32 v59, 0
  v_mov_b32 v63, v119
  v_mov_b32 v62, 0
  v_mov_b32 v66, v119
  v_mov_b32 v67, 0
  v_mov_b32 v71, v119
  v_mov_b32 v70, 0
  v_mov_b32 v74, v119
  v_mov_b32 v75, 0
  v_mov_b32 v79, v119
  v_mov_b32 v78, 0
  v_mov_b32 v82, v119
  v_mov_b32 v83, 0
  v_mov_b32 v87, v119
  v_mov_b32 v86, 0
  s_mov_b32 s90, 0
  s_setprio 0
  s_cmp_gt_u32 s43, 8192
  s_cbranch_scc1 K2_OVER
  s_lshr_b32 s43, s43, 4
  s_branch K2_RANGE
K2_B3:
  s_waitcnt lgkmcnt(0)
  s_barrier
  s_setprio 3
  s_cmp_eq_u32 s45, 0
  s_cbranch_scc1 K2_DONE
  ds_read_b128 v[16:19], v2 offset:0
  ds_read_b128 v[20:23], v2 offset:16
  ds_read_b128 v[24:27], v2 offset:32
  ds_read_b128 v[28:31], v2 offset:48
  ds_read_b32 v7, v6 offset:25344
  ds_read_b32 v8, v6 offset:25348
  ds_read_b32 v5, v6 offset:25340
  ds_read_b128 v[48:51], v2 offset:64
  ds_read2_b32 v[42:43], v3 offset0:0 offset1:2
  s_waitcnt lgkmcnt(5)
  buffer_load_dword v56, v16, s[12:15], 0 offen
  buffer_load_dword v60, v17, s[12:15], 0 offen
  buffer_load_dword v57, v18, s[12:15], 0 offen
  buffer_load_dword v61, v19, s[12:15], 0 offen
  buffer_load_dword v64, v20, s[12:15], 0 offen
  buffer_load_dword v68, v21, s[12:15], 0 offen
  buffer_load_dword v65, v22, s[12:15], 0 offen
  buffer_load_dword v69, v23, s[12:15], 0 offen
  s_waitcnt lgkmcnt(2)
  v_mov_b64 v[32:33], 0
  v_mov_b64 v[34:35], s[36:37]
  v_readfirstlane_b32 s52, v7
  v_readfirstlane_b32 s58, v5
  v_add_u32 v36, 0xffffff00, v7
  v_and_b32 v36, 0x3c00, v36
  s_and_b32 s54, s52, 0xfc
  v_cmp_eq_u32 s[48:49], 0, v36
  s_mul_i32 s55, s54, 132
  v_add_u32 v6, s55, v10
  ds_read2_b64 v[12:15], v6 offset0:0 offset1:0
  s_sub_u32 s56, s45, 1
  s_nop 0
  s_bitset1_b64 s[48:49], s56
  s_and_b32 s58, s58, 0xfc
  s_cmp_eq_u32 s44, 0
  s_cbranch_scc1 K2_OWN
  s_cmp_eq_u32 s58, s54
  s_cbranch_scc0 K2_OWN
  s_lshl_b32 s55, s3, 9
  s_add_u32 s55, s55, 84288
  v_add_u32 v5, s55, v117
  v_mov_b64 v[106:107], 0
  s_lshl_b32 s56, 1, s3
  v_mov_b32 v36, s54
  v_mov_b32 v37, s56
  s_mov_b64 exec, 1
  ds_or_b32 v36, v37 offset:28224
  s_mov_b64 exec, -1
  s_branch K2_LOOP0
K2_OWN:
  v_add_u32 v5, s55, v9
  ds_read2st64_b32 v[106:107], v5 offset0:0 offset1:1
K2_LOOP0:
  buffer_load_dword v72, v24, s[12:15], 0 offen
  buffer_load_dword v76, v25, s[12:15], 0 offen
  buffer_load_dword v73, v26, s[12:15], 0 offen
  buffer_load_dword v77, v27, s[12:15], 0 offen
  buffer_load_dword v80, v28, s[12:15], 0 offen
  buffer_load_dword v84, v29, s[12:15], 0 offen
  buffer_load_dword v81, v30, s[12:15], 0 offen
  buffer_load_dword v85, v31, s[12:15], 0 offen
  s_setprio 2
K2_LOOP:
  s_waitcnt vmcnt(12) lgkmcnt(0)
  v_mfma_f32_16x16x32_bf16 v[16:19], v[40:43], v[56:59], v[12:15]
  v_mfma_f32_16x16x32_bf16 v[20:23], v[40:43], v[60:63], v[12:15]
  buffer_load_dword v56, v48, s[12:15], 0 offen
  buffer_load_dword v60, v49, s[12:15], 0 offen
  buffer_load_dword v57, v50, s[12:15], 0 offen
  buffer_load_dword v61, v51, s[12:15], 0 offen
  ds_read_b128 v[52:55], v2 offset:80
  ds_read2_b32 v[46:47], v3 offset0:8 offset1:10
  s_bitcmp1_b64 s[48:49], s46
  s_cbranch_scc1 K2_SPEC0
  v_exp_f32 v24, v16
  v_exp_f32 v25, v17
  v_exp_f32 v26, v20
  v_exp_f32 v27, v21
  v_exp_f32 v28, v18
  v_exp_f32 v29, v19
  v_exp_f32 v30, v22
  v_exp_f32 v31, v23
  v_pk_fma_f32 v[36:37], v[32:33], v[24:25], v[32:33]
  v_pk_fma_f32 v[32:33], v[16:17], v[34:35], v[36:37]
  v_pk_fma_f32 v[34:35], v[34:35], v[24:25], v[34:35]
  v_pk_fma_f32 v[36:37], v[32:33], v[26:27], v[32:33]
  v_pk_fma_f32 v[32:33], v[20:21], v[34:35], v[36:37]
  v_pk_fma_f32 v[34:35], v[34:35], v[26:27], v[34:35]
  v_pk_fma_f32 v[36:37], v[32:33], v[28:29], v[32:33]
  v_pk_fma_f32 v[32:33], v[18:19], v[34:35], v[36:37]
  v_pk_fma_f32 v[34:35], v[34:35], v[28:29], v[34:35]
  v_pk_fma_f32 v[36:37], v[32:33], v[30:31], v[32:33]
  v_pk_fma_f32 v[32:33], v[22:23], v[34:35], v[36:37]
  v_pk_fma_f32 v[34:35], v[34:35], v[30:31], v[34:35]
K2_NEXT0:
  s_add_u32 s46, s46, 1
  s_waitcnt vmcnt(12) lgkmcnt(0)
  v_mfma_f32_16x16x32_bf16 v[16:19], v[44:47], v[64:67], v[12:15]
  v_mfma_f32_16x16x32_bf16 v[20:23], v[44:47], v[68:71], v[12:15]
  buffer_load_dword v64, v52, s[12:15], 0 offen
  buffer_load_dword v68, v53, s[12:15], 0 offen
  buffer_load_dword v65, v54, s[12:15], 0 offen
  buffer_load_dword v69, v55, s[12:15], 0 offen
  ds_read_b128 v[48:51], v2 offset:96
  ds_read2_b32 v[42:43], v3 offset0:16 offset1:18
  s_bitcmp1_b64 s[48:49], s46
  s_cbranch_scc1 K2_SPEC1
  v_exp_f32 v24, v16
  v_exp_f32 v25, v17
  v_exp_f32 v26, v20
  v_exp_f32 v27, v21
  v_exp_f32 v28, v18
  v_exp_f32 v29, v19
  v_exp_f32 v30, v22
  v_exp_f32 v31, v23
  v_pk_fma_f32 v[36:37], v[32:33], v[24:25], v[32:33]
  v_pk_fma_f32 v[32:33], v[16:17], v[34:35], v[36:37]
  v_pk_fma_f32 v[34:35], v[34:35], v[24:25], v[34:35]
  v_pk_fma_f32 v[36:37], v[32:33], v[26:27], v[32:33]
  v_pk_fma_f32 v[32:33], v[20:21], v[34:35], v[36:37]
  v_pk_fma_f32 v[34:35], v[34:35], v[26:27], v[34:35]
  v_pk_fma_f32 v[36:37], v[32:33], v[28:29], v[32:33]
  v_pk_fma_f32 v[32:33], v[18:19], v[34:35], v[36:37]
  v_pk_fma_f32 v[34:35], v[34:35], v[28:29], v[34:35]
  v_pk_fma_f32 v[36:37], v[32:33], v[30:31], v[32:33]
  v_pk_fma_f32 v[32:33], v[22:23], v[34:35], v[36:37]
  v_pk_fma_f32 v[34:35], v[34:35], v[30:31], v[34:35]
K2_NEXT1:
  s_add_u32 s46, s46, 1
  s_waitcnt vmcnt(12) lgkmcnt(0)
  v_mfma_f32_16x16x32_bf16 v[16:19], v[40:43], v[72:75], v[12:15]
  v_mfma_f32_16x16x32_bf16 v[20:23], v[40:43], v[76:79], v[12:15]
  buffer_load_dword v72, v48, s[12:15], 0 offen
  buffer_load_dword v76, v49, s[12:15], 0 offen
  buffer_load_dword v73, v50, s[12:15], 0 offen
  buffer_load_dword v77, v51, s[12:15], 0 offen
  ds_read_b128 v[52:55], v2 offset:112
  ds_read2_b32 v[46:47], v3 offset0:24 offset1:26
  s_bitcmp1_b64 s[48:49], s46
  s_cbranch_scc1 K2_SPEC2
  v_exp_f32 v24, v16
  v_exp_f32 v25, v17
  v_exp_f32 v26, v20
  v_exp_f32 v27, v21
  v_exp_f32 v28, v18
  v_exp_f32 v29, v19
  v_exp_f32 v30, v22
  v_exp_f32 v31, v23
  v_pk_fma_f32 v[36:37], v[32:33], v[24:25], v[32:33]
  v_pk_fma_f32 v[32:33], v[16:17], v[34:35], v[36:37]
  v_pk_fma_f32 v[34:35], v[34:35], v[24:25], v[34:35]
  v_pk_fma_f32 v[36:37], v[32:33], v[26:27], v[32:33]
  v_pk_fma_f32 v[32:33], v[20:21], v[34:35], v[36:37]
  v_pk_fma_f32 v[34:35], v[34:35], v[26:27], v[34:35]
  v_pk_fma_f32 v[36:37], v[32:33], v[28:29], v[32:33]
  v_pk_fma_f32 v[32:33], v[18:19], v[34:35], v[36:37]
  v_pk_fma_f32 v[34:35], v[34:35], v[28:29], v[34:35]
  v_pk_fma_f32 v[36:37], v[32:33], v[30:31], v[32:33]
  v_pk_fma_f32 v[32:33], v[22:23], v[34:35], v[36:37]
  v_pk_fma_f32 v[34:35], v[34:35], v[30:31], v[34:35]
K2_NEXT2:
  s_add_u32 s46, s46, 1
  s_waitcnt vmcnt(12) lgkmcnt(0)
  v_mfma_f32_16x16x32_bf16 v[16:19], v[44:47], v[80:83], v[12:15]
  v_mfma_f32_16x16x32_bf16 v[20:23], v[44:47], v[84:87], v[12:15]
  buffer_load_dword v80, v52, s[12:15], 0 offen
  buffer_load_dword v84, v53, s[12:15], 0 offen
  buffer_load_dword v81, v54, s[12:15], 0 offen
  buffer_load_dword v85, v55, s[12:15], 0 offen
  ds_read_b128 v[48:51], v2 offset:128
  ds_read2_b32 v[42:43], v3 offset0:32 offset1:34
  s_bitcmp1_b64 s[48:49], s46
  s_cbranch_scc1 K2_SPEC3
  v_exp_f32 v24, v16
  v_exp_f32 v25, v17
  v_exp_f32 v26, v20
  v_exp_f32 v27, v21
  v_exp_f32 v28, v18
  v_exp_f32 v29, v19
  v_exp_f32 v30, v22
  v_exp_f32 v31, v23
  v_pk_fma_f32 v[36:37], v[32:33], v[24:25], v[32:33]
  v_pk_fma_f32 v[32:33], v[16:17], v[34:35], v[36:37]
  v_pk_fma_f32 v[34:35], v[34:35], v[24:25], v[34:35]
  v_pk_fma_f32 v[36:37], v[32:33], v[26:27], v[32:33]
  v_pk_fma_f32 v[32:33], v[20:21], v[34:35], v[36:37]
  v_pk_fma_f32 v[34:35], v[34:35], v[26:27], v[34:35]
  v_pk_fma_f32 v[36:37], v[32:33], v[28:29], v[32:33]
  v_pk_fma_f32 v[32:33], v[18:19], v[34:35], v[36:37]
  v_pk_fma_f32 v[34:35], v[34:35], v[28:29], v[34:35]
  v_pk_fma_f32 v[36:37], v[32:33], v[30:31], v[32:33]
  v_pk_fma_f32 v[32:33], v[22:23], v[34:35], v[36:37]
  v_pk_fma_f32 v[34:35], v[34:35], v[30:31], v[34:35]
K2_NEXT3:
  s_add_u32 s46, s46, 1
  v_add_u32 v2, 64, v2
  v_add_u32 v3, v3, v4
  s_sub_u32 s66, s45, s46
  s_cmp_gt_i32 s66, 12
  s_cbranch_scc1 K2_LOOP
  s_setprio 1
  s_cmp_gt_i32 s66, 5
  s_cbranch_scc1 K2_LOOP
  s_setprio 0
  s_branch K2_LOOP
K2_SPEC0:
  s_mov_b32 s50, 0
  s_branch K2_HANDLER
K2_SPEC1:
  s_mov_b32 s50, 1
  s_branch K2_HANDLER
K2_SPEC2:
  s_mov_b32 s50, 2
  s_branch K2_HANDLER
K2_SPEC3:
  s_mov_b32 s50, 3
K2_HANDLER:
  v_readlane_b32 s52, v7, s46
  v_exp_f32 v24, v16
  v_exp_f32 v25, v17
  s_lshr_b32 s53, s52, 8
  s_min_u32 s53, s53, 4
  s_cmp_lt_u32 s53, 2
  v_pk_fma_f32 v[36:37], v[32:33], v[24:25], v[32:33]
  v_pk_fma_f32 v[32:33], v[16:17], v[34:35], v[36:37]
  v_pk_fma_f32 v[34:35], v[34:35], v[24:25], v[34:35]
  s_cbranch_scc1 K2_FLUSH
  v_exp_f32 v24, v20
  v_exp_f32 v25, v21
  s_cmp_lt_u32 s53, 3
  v_pk_fma_f32 v[36:37], v[32:33], v[24:25], v[32:33]
  v_pk_fma_f32 v[32:33], v[20:21], v[34:35], v[36:37]
  v_pk_fma_f32 v[34:35], v[34:35], v[24:25], v[34:35]
  s_cbranch_scc1 K2_FLUSH
  v_exp_f32 v24, v18
  v_exp_f32 v25, v19
  s_cmp_lt_u32 s53, 4
  v_pk_fma_f32 v[36:37], v[32:33], v[24:25], v[32:33]
  v_pk_fma_f32 v[32:33], v[18:19], v[34:35], v[36:37]
  v_pk_fma_f32 v[34:35], v[34:35], v[24:25], v[34:35]
  s_cbranch_scc1 K2_FLUSH
  v_exp_f32 v24, v22
  v_exp_f32 v25, v23
  s_cmp_lt_u32 s53, 5
  v_pk_fma_f32 v[36:37], v[32:33], v[24:25], v[32:33]
  v_pk_fma_f32 v[32:33], v[22:23], v[34:35], v[36:37]
  v_pk_fma_f32 v[34:35], v[34:35], v[24:25], v[34:35]
K2_FLUSH:
  v_rcp_f32 v38, v34
  v_rcp_f32 v39, v35
  v_readlane_b32 s58, v8, s46
  v_pk_fma_f32 v[38:39], v[32:33], v[38:39], v[106:107]
  v_pk_fma_f32 v[36:37], v[38:39], v[38:39], v[34:35]
  v_cmp_ngt_f32 vcc, s57, v36
  v_cmp_ngt_f32 s[62:63], s57, v37
  s_or_b64 s[62:63], s[62:63], vcc
  s_cbranch_scc1 K2_SLOW
K2_ADD:
  ds_write2st64_b32 v5, v38, v39 offset0:0 offset1:1
  v_mov_b64 v[32:33], 0
  v_mov_b64 v[34:35], s[36:37]
  s_add_u32 s47, s46, 1
  s_cmp_eq_u32 s47, s45
  s_cbranch_scc1 K2_DONE
  s_and_b32 s55, s58, 0xfc
  s_cmp_eq_u32 s55, s54
  s_cbranch_scc0 K2_SWITCH
  v_mov_b64 v[106:107], v[38:39]
  s_branch K2_HRET
K2_SWITCH:
  s_mov_b32 s54, s55
  s_mul_i32 s55, s54, 132
  v_add_u32 v6, s55, v10
  v_add_u32 v5, s55, v9
  ds_read2_b64 v[12:15], v6 offset0:0 offset1:0
  ds_read2st64_b32 v[106:107], v5 offset0:0 offset1:1
K2_HRET:
  s_cmp_eq_u32 s50, 0
  s_cbranch_scc1 K2_NEXT0
  s_cmp_eq_u32 s50, 1
  s_cbranch_scc1 K2_NEXT1
  s_cmp_eq_u32 s50, 2
  s_cbranch_scc1 K2_NEXT2
  s_branch K2_NEXT3
K2_SLOW:
  s_or_b32 s48, s48, 0xaaaaaaaa
  s_or_b32 s49, s49, 0xaaaaaaaa
  v_mov_b32 v104, v106
  v_mov_b32 v105, v107
  s_mov_b32 s67, s47
  v_mov_b32 v92, v40
  v_mov_b32 v93, v41
  v_mov_b32 v98, v119
  v_mov_b32 v99, 0
  v_mov_b32 v102, 0
  v_mov_b32 v103, v119
K2_SLOOP:
  s_add_u32 s55, s44, s67
  s_lshl_b32 s56, s55, 4
  v_mov_b32 v108, s56
  ds_read_b128 v[88:91], v108 offset:0
  v_mad_u32_u24 v109, s55, v115, v113
  ds_read2_b32 v[94:95], v109 offset0:0 offset1:2
  s_waitcnt lgkmcnt(0)
  buffer_load_dword v96, v88, s[12:15], 0 offen
  buffer_load_dword v100, v89, s[12:15], 0 offen
  buffer_load_dword v97, v90, s[12:15], 0 offen
  buffer_load_dword v101, v91, s[12:15], 0 offen
  s_waitcnt vmcnt(0)
  v_mfma_f32_16x16x32_bf16 v[16:19], v[92:95], v[96:99], v[12:15]
  v_mfma_f32_16x16x32_bf16 v[20:23], v[92:95], v[100:103], v[12:15]
  s_mov_b32 s59, 4
  s_cmp_eq_u32 s67, s46
  s_cselect_b32 s59, s53, s59
  s_nop 7
  v_exp_f32 v24, v16
  v_exp_f32 v25, v17
  s_nop 0
  v_add_f32 v24, 1.0, v24
  v_add_f32 v25, 1.0, v25
  v_rcp_f32 v24, v24
  v_rcp_f32 v25, v25
  s_cmp_lt_u32 s59, 2
  v_fma_f32 v104, v16, v24, v104
  v_fma_f32 v105, v17, v25, v105
  s_cbranch_scc1 K2_SNEXT
  v_exp_f32 v24, v20
  v_exp_f32 v25, v21
  s_nop 0
  v_add_f32 v24, 1.0, v24
  v_add_f32 v25, 1.0, v25
  v_rcp_f32 v24, v24
  v_rcp_f32 v25, v25
  s_cmp_lt_u32 s59, 3
  v_fma_f32 v104, v20, v24, v104
  v_fma_f32 v105, v21, v25, v105
  s_cbranch_scc1 K2_SNEXT
  v_exp_f32 v24, v18
  v_exp_f32 v25, v19
  s_nop 0
  v_add_f32 v24, 1.0, v24
  v_add_f32 v25, 1.0, v25
  v_rcp_f32 v24, v24
  v_rcp_f32 v25, v25
  s_cmp_lt_u32 s59, 4
  v_fma_f32 v104, v18, v24, v104
  v_fma_f32 v105, v19, v25, v105
  s_cbranch_scc1 K2_SNEXT
  v_exp_f32 v24, v22
  v_exp_f32 v25, v23
  s_nop 0
  v_add_f32 v24, 1.0, v24
  v_add_f32 v25, 1.0, v25
  v_rcp_f32 v24, v24
  v_rcp_f32 v25, v25
  s_cmp_lt_u32 s59, 5
  v_fma_f32 v104, v22, v24, v104
  v_fma_f32 v105, v23, v25, v105
K2_SNEXT:
  s_add_u32 s67, s67, 1
  s_cmp_le_u32 s67, s46
  s_cbranch_scc1 K2_SLOOP
  v_mov_b32 v38, v104
  v_mov_b32 v39, v105
  s_branch K2_ADD
K2_OVER:
  s_barrier
  v_mov_b32 v16, 0
  v_cmp_gt_u32 vcc, 63, v0
  s_and_saveexec_b64 s[64:65], vcc
  ds_write_b32 v117, v16 offset:27712
  s_mov_b64 exec, s[64:65]
  v_mov_b32 v26, 27964
  v_mov_b32 v27, 1
  ds_write_b32 v26, v27
  s_mov_b64 s[28:29], 0
  s_mov_b64 s[30:31], 0
  s_mov_b64 s[32:33], 0
  s_mov_b64 s[34:35], 0
  s_mov_b64 s[92:93], 0
  s_mov_b64 s[94:95], 0
  s_mov_b64 s[86:87], 0
  s_mov_b32 s42, 6
  s_waitcnt lgkmcnt(0)
  s_barrier
  s_branch K2_HIST
K2_DONE:
  s_setprio 0
  s_waitcnt vmcnt(0)
  s_cmp_lg_u32 s41, 0
  s_cbranch_scc1 K2_NOU2
  s_cmp_ge_u32 s3, 4
  s_cbranch_scc1 K2_NOU
  s_lshl_b32 s55, s3, 13
  s_add_u32 s55, s55, 32768
  s_add_u32 s18, s4, s55
  s_addc_u32 s19, s5, 0
  s_add_u32 s20, s18, 32768
  s_addc_u32 s21, s19, 0
  v_lshlrev_b32 v120, 4, v1
  v_add_u32 v121, 0x1000, v120
  global_load_dwordx4 v[56:59], v120, s[18:19] offset:0
  global_load_dwordx4 v[60:63], v120, s[18:19] offset:1024
  s_waitcnt vmcnt(4)
  global_load_dwordx4 v[64:67], v120, s[18:19] offset:2048
  global_load_dwordx4 v[68:71], v120, s[18:19] offset:3072
  s_waitcnt vmcnt(4)
  global_load_dwordx4 v[72:75], v121, s[18:19] offset:0
  global_load_dwordx4 v[76:79], v121, s[18:19] offset:1024
  s_waitcnt vmcnt(4)
  global_load_dwordx4 v[80:83], v121, s[18:19] offset:2048
  global_load_dwordx4 v[84:87], v121, s[18:19] offset:3072
  s_waitcnt vmcnt(4)
  v_and_b32 v122, 15, v1
  v_lshrrev_b32 v123, 4, v1
  v_mul_u32_u24 v122, 272, v122
  v_lshl_add_u32 v122, v123, 4, v122
  global_load_dwordx4 v[88:91], v120, s[20:21] offset:0
  global_load_dwordx4 v[92:95], v120, s[20:21] offset:1024
  s_waitcnt vmcnt(4)
  global_load_dwordx4 v[96:99], v120, s[20:21] offset:2048
  global_load_dwordx4 v[100:103], v120, s[20:21] offset:3072
  s_waitcnt vmcnt(4)
  global_load_dwordx4 v[104:107], v121, s[20:21] offset:0
  global_load_dwordx4 v[108:111], v121, s[20:21] offset:1024
  s_waitcnt vmcnt(4)
  global_load_dwordx4 v[112:115], v121, s[20:21] offset:2048
  global_load_dwordx4 v[116:119], v121, s[20:21] offset:3072
  s_waitcnt vmcnt(4)
  ds_read_b128 v[40:43], v122 offset:50112
  ds_read_b128 v[44:47], v122 offset:50176
  ds_read_b128 v[48:51], v122 offset:50240
  ds_read_b128 v[52:55], v122 offset:50304
  s_waitcnt vmcnt(8)
  s_waitcnt lgkmcnt(3)
  v_mfma_f32_16x16x32_bf16 v[16:19], v[56:59], v[40:43], 0
  v_mfma_f32_16x16x32_bf16 v[20:23], v[72:75], v[40:43], 0
  ds_read_b128 v[40:43], v122 offset:54464
  s_waitcnt lgkmcnt(3)
  v_mfma_f32_16x16x32_bf16 v[16:19], v[60:63], v[44:47], v[16:19]
  v_mfma_f32_16x16x32_bf16 v[20:23], v[76:79], v[44:47], v[20:23]
  ds_read_b128 v[44:47], v122 offset:54528
  s_waitcnt lgkmcnt(3)
  v_mfma_f32_16x16x32_bf16 v[16:19], v[64:67], v[48:51], v[16:19]
  v_mfma_f32_16x16x32_bf16 v[20:23], v[80:83], v[48:51], v[20:23]
  ds_read_b128 v[48:51], v122 offset:54592
  s_waitcnt lgkmcnt(3)
  v_mfma_f32_16x16x32_bf16 v[16:19], v[68:71], v[52:55], v[16:19]
  v_mfma_f32_16x16x32_bf16 v[20:23], v[84:87], v[52:55], v[20:23]
  ds_read_b128 v[52:55], v122 offset:54656
  s_waitcnt lgkmcnt(3)
  v_mfma_f32_16x16x32_bf16 v[24:27], v[56:59], v[40:43], 0
  v_mfma_f32_16x16x32_bf16 v[28:31], v[72:75], v[40:43], 0
  ds_read_b128 v[40:43], v122 offset:58816
  s_waitcnt lgkmcnt(3)
  v_mfma_f32_16x16x32_bf16 v[24:27], v[60:63], v[44:47], v[24:27]
  v_mfma_f32_16x16x32_bf16 v[28:31], v[76:79], v[44:47], v[28:31]
  ds_read_b128 v[44:47], v122 offset:58880
  s_waitcnt lgkmcnt(3)
  v_mfma_f32_16x16x32_bf16 v[24:27], v[64:67], v[48:51], v[24:27]
  v_mfma_f32_16x16x32_bf16 v[28:31], v[80:83], v[48:51], v[28:31]
  ds_read_b128 v[48:51], v122 offset:58944
  s_waitcnt lgkmcnt(3)
  v_mfma_f32_16x16x32_bf16 v[24:27], v[68:71], v[52:55], v[24:27]
  v_mfma_f32_16x16x32_bf16 v[28:31], v[84:87], v[52:55], v[28:31]
  ds_read_b128 v[52:55], v122 offset:59008
  s_waitcnt lgkmcnt(3)
  v_mfma_f32_16x16x32_bf16 v[32:35], v[56:59], v[40:43], 0
  v_mfma_f32_16x16x32_bf16 v[36:39], v[72:75], v[40:43], 0
  s_waitcnt lgkmcnt(2)
  v_mfma_f32_16x16x32_bf16 v[32:35], v[60:63], v[44:47], v[32:35]
  v_mfma_f32_16x16x32_bf16 v[36:39], v[76:79], v[44:47], v[36:39]
  s_waitcnt lgkmcnt(1)
  v_mfma_f32_16x16x32_bf16 v[32:35], v[64:67], v[48:51], v[32:35]
  v_mfma_f32_16x16x32_bf16 v[36:39], v[80:83], v[48:51], v[36:39]
  s_waitcnt lgkmcnt(0)
  v_mfma_f32_16x16x32_bf16 v[32:35], v[68:71], v[52:55], v[32:35]
  v_mfma_f32_16x16x32_bf16 v[36:39], v[84:87], v[52:55], v[36:39]
  v_and_b32 v120, 15, v1
  v_lshrrev_b32 v121, 4, v1
  v_add_u32 v123, s88, v120
  v_lshlrev_b32 v123, 8, v123
  v_lshl_add_u32 v123, v121, 4, v123
  s_lshl_b32 s59, s3, 6
  v_add_u32 v123, s59, v123
  s_mov_b32 s16, 0xbfb8aa3b
  s_mov_b32 s17, 0xbfb8aa3b
  s_sub_u32 s59, s89, 32
  v_cmp_gt_u32 s[68:69], s59, v120
  v_add_u32 v124, 0x1000, v123
  v_add_u32 v125, 0x2000, v123
  s_branch K2_NOU2
K2_NOU:
  v_subrev_u32 v40, 256, v0
  v_lshrrev_b32 v41, 4, v40
  v_and_b32 v40, 15, v40
  v_mul_u32_u24 v42, 528, v41
  v_lshl_add_u32 v42, v40, 5, v42
  v_lshlrev_b32 v43, 2, v41
  v_lshlrev_b32 v44, 5, v40
  v_add_u32 v44, 84288, v44
  v_mul_u32_u24 v45, 272, v41
  v_lshl_add_u32 v45, v40, 4, v45
  s_mov_b32 s16, 0xbf317218
  s_mov_b32 s17, 0xbf317218
K2_NOU2:
  s_waitcnt lgkmcnt(0)
  s_barrier
  s_cmp_eq_u32 s41, 0
  s_cbranch_scc1 K2_EPI
  v_subrev_u32 v31, 0, v0
  v_lshrrev_b32 v16, 4, v31
  v_and_b32 v17, 15, v31
  v_mul_u32_u24 v18, 528, v16
  v_lshl_add_u32 v18, v17, 5, v18
  v_lshlrev_b32 v19, 2, v16
  v_mov_b32 v30, 640
  v_cmp_gt_u32 vcc, v30, v31
  s_and_saveexec_b64 s[64:65], vcc
  s_cbranch_execz K2_M9R
  ds_read_b32 v29, v19 offset:28224
  ds_read_b128 v[20:23], v18 offset:28992
  ds_read_b128 v[24:27], v18 offset:29008
  s_mov_b64 s[62:63], exec
  v_lshlrev_b32 v30, 5, v17
  v_add_u32 v30, 84288, v30
  s_waitcnt lgkmcnt(2)
K2_M1R:
  v_cmp_ne_u32 vcc, 0, v29
  s_and_b64 exec, exec, vcc
  s_cbranch_execz K2_M2R
  v_ffbl_b32 v28, v29
  v_add_u32 v31, -1, v29
  v_lshl_add_u32 v28, v28, 9, v30
  v_and_b32 v29, v29, v31
  ds_read_b128 v[32:35], v28
  ds_read_b128 v[36:39], v28 offset:16
  s_waitcnt lgkmcnt(0)
  v_pk_add_f32 v[20:21], v[20:21], v[32:33]
  v_pk_add_f32 v[22:23], v[22:23], v[34:35]
  v_pk_add_f32 v[24:25], v[24:25], v[36:37]
  v_pk_add_f32 v[26:27], v[26:27], v[38:39]
  s_branch K2_M1R
K2_M2R:
  s_mov_b64 exec, s[62:63]
  s_waitcnt lgkmcnt(0)
  ds_write_b128 v18, v[20:23] offset:28992
  ds_write_b128 v18, v[24:27] offset:29008
K2_M9R:
  s_mov_b64 exec, s[64:65]
  s_add_u32 s40, s40, s42
  s_waitcnt lgkmcnt(0)
  s_barrier
  v_mov_b32 v16, 0
  v_cmp_gt_u32 vcc, 256, v0
  s_and_saveexec_b64 s[64:65], vcc
  v_lshlrev_b32 v17, 2, v0
  ds_write_b32 v17, v16 offset:27712
  s_mov_b64 exec, s[64:65]
  s_waitcnt lgkmcnt(0)
  s_barrier
  s_branch K2_ROUND
K2_EPI:
  s_cmp_lt_u32 s3, 4
  s_cbranch_scc1 K2_MF9
  s_cmp_ge_u32 s3, 14
  s_cbranch_scc1 K2_MF9
  ds_read_b32 v29, v43 offset:28224
  ds_read_b128 v[20:23], v42 offset:28992
  ds_read_b128 v[24:27], v42 offset:29008
  s_waitcnt lgkmcnt(2)
K2_MF1:
  v_cmp_ne_u32 vcc, 0, v29
  s_and_b64 exec, exec, vcc
  s_cbranch_execz K2_MF2
  v_ffbl_b32 v28, v29
  v_add_u32 v31, -1, v29
  v_lshl_add_u32 v28, v28, 9, v44
  v_and_b32 v29, v29, v31
  ds_read_b128 v[32:35], v28
  ds_read_b128 v[36:39], v28 offset:16
  s_waitcnt lgkmcnt(0)
  v_pk_add_f32 v[20:21], v[20:21], v[32:33]
  v_pk_add_f32 v[22:23], v[22:23], v[34:35]
  v_pk_add_f32 v[24:25], v[24:25], v[36:37]
  v_pk_add_f32 v[26:27], v[26:27], v[38:39]
  s_branch K2_MF1
K2_MF2:
  s_mov_b64 exec, -1
  s_waitcnt lgkmcnt(0)
  v_pk_mul_f32 v[20:21], v[20:21], s[16:17]
  v_pk_mul_f32 v[22:23], v[22:23], s[16:17]
  v_pk_mul_f32 v[24:25], v[24:25], s[16:17]
  v_pk_mul_f32 v[26:27], v[26:27], s[16:17]
  v_cvt_pk_bf16_f32 v28, v20, v21
  v_cvt_pk_bf16_f32 v29, v22, v23
  v_cvt_pk_bf16_f32 v30, v24, v25
  v_cvt_pk_bf16_f32 v31, v26, v27
  ds_write_b128 v45, v[28:31] offset:50112
K2_MF9:
  s_waitcnt lgkmcnt(0)
  s_barrier
  s_cmp_ge_u32 s3, 4
  s_cbranch_scc1 K2_END
  ds_read_b128 v[40:43], v122 offset:50112
  ds_read_b128 v[44:47], v122 offset:50176
  ds_read_b128 v[48:51], v122 offset:50240
  ds_read_b128 v[52:55], v122 offset:50304
  ds_read_b128 v[56:59], v122 offset:54464
  ds_read_b128 v[60:63], v122 offset:54528
  ds_read_b128 v[64:67], v122 offset:54592
  ds_read_b128 v[68:71], v122 offset:54656
  ds_read_b128 v[72:75], v122 offset:58816
  ds_read_b128 v[76:79], v122 offset:58880
  ds_read_b128 v[80:83], v122 offset:58944
  ds_read_b128 v[84:87], v122 offset:59008
  s_waitcnt vmcnt(0)
  s_waitcnt lgkmcnt(11)
  v_mfma_f32_16x16x32_bf16 v[16:19], v[88:91], v[40:43], v[16:19]
  v_mfma_f32_16x16x32_bf16 v[20:23], v[104:107], v[40:43], v[20:23]
  s_waitcnt lgkmcnt(10)
  v_mfma_f32_16x16x32_bf16 v[16:19], v[92:95], v[44:47], v[16:19]
  v_mfma_f32_16x16x32_bf16 v[20:23], v[108:111], v[44:47], v[20:23]
  s_waitcnt lgkmcnt(9)
  v_mfma_f32_16x16x32_bf16 v[16:19], v[96:99], v[48:51], v[16:19]
  v_mfma_f32_16x16x32_bf16 v[20:23], v[112:115], v[48:51], v[20:23]
  s_waitcnt lgkmcnt(8)
  v_mfma_f32_16x16x32_bf16 v[16:19], v[100:103], v[52:55], v[16:19]
  v_mfma_f32_16x16x32_bf16 v[20:23], v[116:119], v[52:55], v[20:23]
  s_waitcnt lgkmcnt(7)
  v_mfma_f32_16x16x32_bf16 v[24:27], v[88:91], v[56:59], v[24:27]
  v_mfma_f32_16x16x32_bf16 v[28:31], v[104:107], v[56:59], v[28:31]
  s_waitcnt lgkmcnt(6)
  v_mfma_f32_16x16x32_bf16 v[24:27], v[92:95], v[60:63], v[24:27]
  v_mfma_f32_16x16x32_bf16 v[28:31], v[108:111], v[60:63], v[28:31]
  s_waitcnt lgkmcnt(5)
  v_mfma_f32_16x16x32_bf16 v[24:27], v[96:99], v[64:67], v[24:27]
  v_mfma_f32_16x16x32_bf16 v[28:31], v[112:115], v[64:67], v[28:31]
  s_waitcnt lgkmcnt(4)
  v_mfma_f32_16x16x32_bf16 v[24:27], v[100:103], v[68:71], v[24:27]
  v_mfma_f32_16x16x32_bf16 v[28:31], v[116:119], v[68:71], v[28:31]
  v_pk_mul_f32 v[40:41], v[16:17], s[16:17]
  v_pk_mul_f32 v[42:43], v[18:19], s[16:17]
  v_pk_mul_f32 v[44:45], v[20:21], s[16:17]
  v_pk_mul_f32 v[46:47], v[22:23], s[16:17]
  v_exp_f32 v40, v40
  v_exp_f32 v41, v41
  v_exp_f32 v42, v42
  v_exp_f32 v43, v43
  v_exp_f32 v44, v44
  v_exp_f32 v45, v45
  v_exp_f32 v46, v46
  v_exp_f32 v47, v47
  s_nop 0
  v_pk_add_f32 v[40:41], v[40:41], s[36:37]
  v_pk_add_f32 v[42:43], v[42:43], s[36:37]
  v_pk_add_f32 v[44:45], v[44:45], s[36:37]
  v_pk_add_f32 v[46:47], v[46:47], s[36:37]
  v_rcp_f32 v40, v40
  v_rcp_f32 v41, v41
  v_rcp_f32 v42, v42
  v_rcp_f32 v43, v43
  v_rcp_f32 v44, v44
  v_rcp_f32 v45, v45
  v_rcp_f32 v46, v46
  v_rcp_f32 v47, v47
  s_nop 0
  v_pk_mul_f32 v[40:41], v[16:17], v[40:41]
  v_pk_mul_f32 v[42:43], v[18:19], v[42:43]
  v_pk_mul_f32 v[44:45], v[20:21], v[44:45]
  v_pk_mul_f32 v[46:47], v[22:23], v[46:47]
  v_cvt_pk_bf16_f32 v12, v40, v41
  v_cvt_pk_bf16_f32 v13, v42, v43
  v_cvt_pk_bf16_f32 v14, v44, v45
  v_cvt_pk_bf16_f32 v15, v46, v47
  global_store_dwordx4 v123, v[12:15], s[8:9] sc1
  s_waitcnt lgkmcnt(3)
  v_mfma_f32_16x16x32_bf16 v[32:35], v[88:91], v[72:75], v[32:35]
  v_mfma_f32_16x16x32_bf16 v[36:39], v[104:107], v[72:75], v[36:39]
  s_waitcnt lgkmcnt(2)
  v_mfma_f32_16x16x32_bf16 v[32:35], v[92:95], v[76:79], v[32:35]
  v_mfma_f32_16x16x32_bf16 v[36:39], v[108:111], v[76:79], v[36:39]
  s_waitcnt lgkmcnt(1)
  v_mfma_f32_16x16x32_bf16 v[32:35], v[96:99], v[80:83], v[32:35]
  v_mfma_f32_16x16x32_bf16 v[36:39], v[112:115], v[80:83], v[36:39]
  s_waitcnt lgkmcnt(0)
  v_mfma_f32_16x16x32_bf16 v[32:35], v[100:103], v[84:87], v[32:35]
  v_mfma_f32_16x16x32_bf16 v[36:39], v[116:119], v[84:87], v[36:39]
  v_pk_mul_f32 v[48:49], v[24:25], s[16:17]
  v_pk_mul_f32 v[50:51], v[26:27], s[16:17]
  v_pk_mul_f32 v[52:53], v[28:29], s[16:17]
  v_pk_mul_f32 v[54:55], v[30:31], s[16:17]
  v_exp_f32 v48, v48
  v_exp_f32 v49, v49
  v_exp_f32 v50, v50
  v_exp_f32 v51, v51
  v_exp_f32 v52, v52
  v_exp_f32 v53, v53
  v_exp_f32 v54, v54
  v_exp_f32 v55, v55
  s_nop 0
  v_pk_add_f32 v[48:49], v[48:49], s[36:37]
  v_pk_add_f32 v[50:51], v[50:51], s[36:37]
  v_pk_add_f32 v[52:53], v[52:53], s[36:37]
  v_pk_add_f32 v[54:55], v[54:55], s[36:37]
  v_rcp_f32 v48, v48
  v_rcp_f32 v49, v49
  v_rcp_f32 v50, v50
  v_rcp_f32 v51, v51
  v_rcp_f32 v52, v52
  v_rcp_f32 v53, v53
  v_rcp_f32 v54, v54
  v_rcp_f32 v55, v55
  s_nop 0
  v_pk_mul_f32 v[48:49], v[24:25], v[48:49]
  v_pk_mul_f32 v[50:51], v[26:27], v[50:51]
  v_pk_mul_f32 v[52:53], v[28:29], v[52:53]
  v_pk_mul_f32 v[54:55], v[30:31], v[54:55]
  v_cvt_pk_bf16_f32 v64, v48, v49
  v_cvt_pk_bf16_f32 v65, v50, v51
  v_cvt_pk_bf16_f32 v66, v52, v53
  v_cvt_pk_bf16_f32 v67, v54, v55
  global_store_dwordx4 v124, v[64:67], s[8:9] sc1
  s_nop 7
  v_pk_mul_f32 v[56:57], v[32:33], s[16:17]
  v_pk_mul_f32 v[58:59], v[34:35], s[16:17]
  v_pk_mul_f32 v[60:61], v[36:37], s[16:17]
  v_pk_mul_f32 v[62:63], v[38:39], s[16:17]
  v_exp_f32 v56, v56
  v_exp_f32 v57, v57
  v_exp_f32 v58, v58
  v_exp_f32 v59, v59
  v_exp_f32 v60, v60
  v_exp_f32 v61, v61
  v_exp_f32 v62, v62
  v_exp_f32 v63, v63
  s_nop 0
  v_pk_add_f32 v[56:57], v[56:57], s[36:37]
  v_pk_add_f32 v[58:59], v[58:59], s[36:37]
  v_pk_add_f32 v[60:61], v[60:61], s[36:37]
  v_pk_add_f32 v[62:63], v[62:63], s[36:37]
  v_rcp_f32 v56, v56
  v_rcp_f32 v57, v57
  v_rcp_f32 v58, v58
  v_rcp_f32 v59, v59
  v_rcp_f32 v60, v60
  v_rcp_f32 v61, v61
  v_rcp_f32 v62, v62
  v_rcp_f32 v63, v63
  s_nop 0
  v_pk_mul_f32 v[56:57], v[32:33], v[56:57]
  v_pk_mul_f32 v[58:59], v[34:35], v[58:59]
  v_pk_mul_f32 v[60:61], v[36:37], v[60:61]
  v_pk_mul_f32 v[62:63], v[38:39], v[62:63]
  v_cvt_pk_bf16_f32 v68, v56, v57
  v_cvt_pk_bf16_f32 v69, v58, v59
  v_cvt_pk_bf16_f32 v70, v60, v61
  v_cvt_pk_bf16_f32 v71, v62, v63
  s_mov_b64 exec, s[68:69]
  global_store_dwordx4 v125, v[68:71], s[8:9] sc1
K2_END:
  s_endpgm
  .section .rodata,"a"
  .p2align 6
  .amdhsa_kernel mpnn_k2_kernel
  .amdhsa_next_free_vgpr 128
  .amdhsa_next_free_sgpr 102
  .amdhsa_accum_offset 128
  .amdhsa_group_segment_fixed_size 0
  .amdhsa_kernarg_size 72
  .amdhsa_user_sgpr_count 2
  .amdhsa_user_sgpr_kernarg_segment_ptr 1
  .amdhsa_system_sgpr_workgroup_id_x 1
  .amdhsa_float_denorm_mode_32 3
  .end_amdhsa_kernel
  .text
```
